```python
import torch

def _softmax(x, axis=-1):
    return torch.softmax(x, dim=axis)
def _gelu(x):
    return torch.nn.functional.gelu(x, approximate="tanh")
def _silu(x):
    return torch.nn.functional.silu(x)
def _sigmoid(x):
    return torch.sigmoid(x)
def _layernorm(x, axis=-1, eps=1e-5):
    m = x.mean(dim=axis, keepdim=True)
    v = x.var(dim=axis, keepdim=True, unbiased=False)
    return (x - m) / torch.sqrt(v + eps)
def _scatter_add(tgt, idx, src, axis=0):
    return tgt.clone().index_add_(axis, idx, src)
def _segment_sum(src, seg, n):
    out = torch.zeros((n,) + src.shape[1:], dtype=src.dtype)
    return out.index_add_(0, seg, src)
def _pad(x, pw):
    flat = tuple(v for pair in reversed(pw) for v in pair)
    return torch.nn.functional.pad(x, flat)

kernel_name = 'standalone__gqa_softmax__sampling'

def setup_inputs():

    _w = (lambda a: (lambda t: t.to(torch.bfloat16) if t.is_floating_point() else t)(torch.as_tensor(a)))
    B, Hq, Hkv, Sq, Sk, D = 8, 32, 8, 1, 8192, 128
    return {
        "q": _w((lambda *s: torch.randn(*s, dtype=torch.bfloat16) * 0.8)(B, Hq, Sq, D)),
        "k": _w((lambda *s: torch.randn(*s, dtype=torch.bfloat16) * 0.8)(B, Hkv, Sk, D)),
        "v": _w((lambda *s: torch.randn(*s, dtype=torch.bfloat16) * 0.05)(B, Hkv, Sk, D)),
    }

def reference(q, k, v):
    B, Hq, Sq, D = q.shape
    Hkv = k.shape[1]
    rep = Hq // Hkv
    k = (lambda x, n, axis: torch.repeat_interleave(x, n, dim=axis))(k, rep, axis=1)
    v = (lambda x, n, axis: torch.repeat_interleave(x, n, dim=axis))(v, rep, axis=1)
    scale = D ** -0.5
    scores = torch.einsum("bhqd,bhkd->bhqk", q, k) * scale
    p = _softmax(scores, axis=-1)
    return torch.einsum("bhqk,bhkd->bhqd", p, v)
```

```asm
; @launch grid=(256,1,1) block=(256,1,1) lds=8384
.amdgcn_target "amdgcn-amd-amdhsa--gfx950"
.text
.globl standalone__gqa_softmax__sampling_kernel
.p2align 8
.type standalone__gqa_softmax__sampling_kernel,@function
standalone__gqa_softmax__sampling_kernel:
    s_load_dwordx4 s[4:7], s[0:1], 0
    s_load_dwordx4 s[8:11], s[0:1], 16
    s_load_dwordx4 s[12:15], s[0:1], 32
    s_cmp_ge_u32 s2, 256
    s_cbranch_scc1 L_end
    s_and_b32 s3, s2, 0x0
    s_bitcmp1_b32 s2, 0
    s_cselect_b32 s41, 0x8, 0
    s_or_b32 s3, s3, s41
    s_bitcmp1_b32 s2, 1
    s_cselect_b32 s41, 0x1, 0
    s_or_b32 s3, s3, s41
    s_bitcmp1_b32 s2, 2
    s_cselect_b32 s41, 0x80, 0
    s_or_b32 s3, s3, s41
    s_bitcmp1_b32 s2, 3
    s_cselect_b32 s41, 0x40, 0
    s_or_b32 s3, s3, s41
    s_bitcmp1_b32 s2, 4
    s_cselect_b32 s41, 0x20, 0
    s_or_b32 s3, s3, s41
    s_bitcmp1_b32 s2, 5
    s_cselect_b32 s41, 0x4, 0
    s_or_b32 s3, s3, s41
    s_bitcmp1_b32 s2, 6
    s_cselect_b32 s41, 0x10, 0
    s_or_b32 s3, s3, s41
    s_bitcmp1_b32 s2, 7
    s_cselect_b32 s41, 0x2, 0
    s_or_b32 s3, s3, s41
    s_mov_b32 s2, s3
    v_and_b32 v3, 63, v0
    v_lshrrev_b32 v59, 6, v0
    v_and_b32 v58, 3, v0
    v_bfe_u32 v57, v0, 2, 2
    v_bfe_u32 v60, v0, 4, 2
    v_lshlrev_b32 v60, 6, v60
    v_readfirstlane_b32 s44, v59
    v_lshl_add_u32 v1, v58, 4, v60
    v_lshl_add_u32 v1, v57, 8, v1
    v_lshl_add_u32 v56, v58, 8, v60
    v_lshl_add_u32 v56, v57, 4, v56
    v_lshlrev_b32 v2, 4, v3
    s_lshr_b32 s55, s2, 2
    s_lshl_b32 s55, s55, 21
    s_bitcmp1_b32 s2, 0
    s_cselect_b32 s41, 0x7d000, 0
    s_xor_b32 s55, s55, s41
    s_bitcmp1_b32 s2, 1
    s_cselect_b32 s41, 0x102000, 0
    s_xor_b32 s55, s55, s41
    s_bitcmp1_b32 s44, 0
    s_cselect_b32 s41, 0x2000, 0
    s_xor_b32 s55, s55, s41
    s_bitcmp1_b32 s44, 1
    s_cselect_b32 s41, 0x81000, 0
    s_xor_b32 s55, s55, s41
    s_lshr_b32 s42, s2, 2
    s_lshl_b32 s43, s42, 10
    s_mov_b32 s18, 0x8000000
    s_mov_b32 s19, 0x20000
    s_mov_b32 s26, 0x10000
    s_mov_b32 s27, 0x20000
    s_waitcnt lgkmcnt(0)
    s_mov_b32 s16, s6
    s_and_b32 s17, s7, 0xffff
    s_mov_b32 s24, s4
    s_and_b32 s25, s5, 0xffff
    buffer_load_dwordx4 v[4:7], v56, s[24:27], s43 offen
    buffer_load_dwordx4 v[120:123], v1, s[16:19], s55 offen offset:0 nt
    buffer_load_dwordx4 v[124:127], v1, s[16:19], s55 offen offset:1024 nt
    buffer_load_dwordx4 v[128:131], v1, s[16:19], s55 offen offset:2048 nt
    buffer_load_dwordx4 v[132:135], v1, s[16:19], s55 offen offset:3072 nt
    s_xor_b32 s36, s55, 0xa000
    buffer_load_dwordx4 v[136:139], v1, s[16:19], s36 offen offset:0 nt
    s_mov_b32 s20, s8
    s_and_b32 s21, s9, 0xffff
    s_mov_b32 s22, 0x8000000
    s_mov_b32 s23, 0x20000
    s_mov_b32 s38, 0x3e0293ee
    s_mov_b32 s39, 0x05040100
    s_mov_b32 s40, 0x07060302
    s_mov_b32 s28, s14
    s_and_b32 s29, s15, 0xffff
    s_mov_b32 s30, 0x100000
    s_mov_b32 s31, 0x20000
    s_mov_b32 s32, s10
    s_and_b32 s33, s11, 0xffff
    s_mov_b32 s34, 0x10000
    s_mov_b32 s35, 0x20000
    s_lshl_b32 s42, s42, 2
    s_add_u32 s12, s12, s42
    s_addc_u32 s13, s13, 0
    s_lshl_b32 s41, s44, 10
    s_lshl_b32 s53, s2, 12
    s_add_u32 s53, s53, s41
    s_xor_b32 s47, s53, 4096
    s_xor_b32 s48, s53, 8192
    s_xor_b32 s49, s53, 12288
    v_and_b32 v86, 3, v0
    v_lshlrev_b32 v86, 9, v86
    v_bfe_u32 v87, v0, 2, 4
    v_lshl_add_u32 v86, v87, 4, v86
    s_lshl_b32 s41, s44, 2
    v_add_u32 v86, s41, v86
    v_mov_b32 v87, s41
    s_lshl_b32 s41, s44, 8
    s_add_u32 s43, s43, s41
    v_mov_b32 v64, 0
    v_mov_b32 v65, 0
    v_mov_b32 v66, 0
    v_mov_b32 v67, 0
    s_mov_b32 s41, s53
    buffer_store_dwordx4 v[64:67], v2, s[28:31], s41 offen sc1
    ds_write_b64 v64, v[64:65] offset:0
    s_waitcnt lgkmcnt(0)
    s_barrier
    s_waitcnt vmcnt(5)
    buffer_load_dwordx4 v[140:143], v1, s[16:19], s36 offen offset:1024 nt
    s_waitcnt vmcnt(5)
    buffer_load_dwordx4 v[144:147], v1, s[16:19], s36 offen offset:2048 nt
    s_waitcnt vmcnt(5)
    buffer_load_dwordx4 v[148:151], v1, s[16:19], s36 offen offset:3072 nt
    s_waitcnt vmcnt(5)
    s_xor_b32 s36, s55, 0x10000
    buffer_load_dwordx4 v[152:155], v1, s[16:19], s36 offen offset:0 nt
    v_mfma_f32_16x16x32_bf16 v[8:11], v[120:123], v[4:7], 0
    v_mfma_f32_16x16x32_bf16 v[12:15], v[124:127], v[4:7], 0
    v_mfma_f32_16x16x32_bf16 v[16:19], v[128:131], v[4:7], 0
    v_mfma_f32_16x16x32_bf16 v[20:23], v[132:135], v[4:7], 0
    s_nop 4
    s_waitcnt vmcnt(5)
    buffer_load_dwordx4 v[156:159], v1, s[16:19], s36 offen offset:1024 nt
    s_nop 2
    v_add_f32_dpp v57, v9, v8 row_ror:12 row_mask:0xf bank_mask:0x1
    v_add_f32_dpp v57, v11, v10 row_ror:12 row_mask:0xf bank_mask:0x4
    v_add_f32_dpp v57, v14, v13 row_ror:12 row_mask:0xf bank_mask:0x2
    v_add_f32_dpp v57, v12, v15 row_ror:12 row_mask:0xf bank_mask:0x8
    v_add_f32_dpp v58, v17, v16 row_ror:12 row_mask:0xf bank_mask:0x1
    v_add_f32_dpp v58, v19, v18 row_ror:12 row_mask:0xf bank_mask:0x4
    v_add_f32_dpp v58, v22, v21 row_ror:12 row_mask:0xf bank_mask:0x2
    v_add_f32_dpp v58, v20, v23 row_ror:12 row_mask:0xf bank_mask:0x8
    v_add_f32_dpp v88, v57, v57 row_ror:8 row_mask:0xf bank_mask:0x3
    s_nop 0
    v_add_f32_dpp v88, v58, v58 row_ror:8 row_mask:0xf bank_mask:0xc
    v_mov_b32 v56, v88
    s_waitcnt vmcnt(4)
    buffer_load_dwordx4 v[160:163], v1, s[16:19], s36 offen offset:2048 nt
    s_waitcnt vmcnt(4)
    buffer_load_dwordx4 v[164:167], v1, s[16:19], s36 offen offset:3072 nt
    s_waitcnt vmcnt(4)
    s_xor_b32 s36, s55, 0x1a000
    buffer_load_dwordx4 v[168:171], v1, s[16:19], s36 offen offset:0 nt
    v_mfma_f32_16x16x32_bf16 v[8:11], v[136:139], v[4:7], 0
    v_mfma_f32_16x16x32_bf16 v[12:15], v[140:143], v[4:7], 0
    v_mfma_f32_16x16x32_bf16 v[16:19], v[144:147], v[4:7], 0
    v_mfma_f32_16x16x32_bf16 v[20:23], v[148:151], v[4:7], 0
    s_nop 4
    s_waitcnt vmcnt(4)
    buffer_load_dwordx4 v[172:175], v1, s[16:19], s36 offen offset:1024 nt
    s_nop 2
    v_add_f32_dpp v57, v9, v8 row_ror:12 row_mask:0xf bank_mask:0x1
    v_add_f32_dpp v57, v11, v10 row_ror:12 row_mask:0xf bank_mask:0x4
    v_add_f32_dpp v57, v14, v13 row_ror:12 row_mask:0xf bank_mask:0x2
    v_add_f32_dpp v57, v12, v15 row_ror:12 row_mask:0xf bank_mask:0x8
    v_add_f32_dpp v58, v17, v16 row_ror:12 row_mask:0xf bank_mask:0x1
    v_add_f32_dpp v58, v19, v18 row_ror:12 row_mask:0xf bank_mask:0x4
    v_add_f32_dpp v58, v22, v21 row_ror:12 row_mask:0xf bank_mask:0x2
    v_add_f32_dpp v58, v20, v23 row_ror:12 row_mask:0xf bank_mask:0x8
    v_add_f32_dpp v89, v57, v57 row_ror:8 row_mask:0xf bank_mask:0x3
    s_nop 0
    v_add_f32_dpp v89, v58, v58 row_ror:8 row_mask:0xf bank_mask:0xc
    v_max_f32 v56, v56, v89
    s_waitcnt vmcnt(4)
    buffer_load_dwordx4 v[176:179], v1, s[16:19], s36 offen offset:2048 nt
    s_waitcnt vmcnt(4)
    buffer_load_dwordx4 v[180:183], v1, s[16:19], s36 offen offset:3072 nt
    s_waitcnt vmcnt(4)
    s_xor_b32 s36, s55, 0x40000
    buffer_load_dwordx4 v[184:187], v1, s[16:19], s36 offen offset:0 nt
    v_mfma_f32_16x16x32_bf16 v[8:11], v[152:155], v[4:7], 0
    v_mfma_f32_16x16x32_bf16 v[12:15], v[156:159], v[4:7], 0
    v_mfma_f32_16x16x32_bf16 v[16:19], v[160:163], v[4:7], 0
    v_mfma_f32_16x16x32_bf16 v[20:23], v[164:167], v[4:7], 0
    s_nop 4
    s_waitcnt vmcnt(4)
    buffer_load_dwordx4 v[188:191], v1, s[16:19], s36 offen offset:1024 nt
    s_nop 2
    v_add_f32_dpp v57, v9, v8 row_ror:12 row_mask:0xf bank_mask:0x1
    v_add_f32_dpp v57, v11, v10 row_ror:12 row_mask:0xf bank_mask:0x4
    v_add_f32_dpp v57, v14, v13 row_ror:12 row_mask:0xf bank_mask:0x2
    v_add_f32_dpp v57, v12, v15 row_ror:12 row_mask:0xf bank_mask:0x8
    v_add_f32_dpp v58, v17, v16 row_ror:12 row_mask:0xf bank_mask:0x1
    v_add_f32_dpp v58, v19, v18 row_ror:12 row_mask:0xf bank_mask:0x4
    v_add_f32_dpp v58, v22, v21 row_ror:12 row_mask:0xf bank_mask:0x2
    v_add_f32_dpp v58, v20, v23 row_ror:12 row_mask:0xf bank_mask:0x8
    v_add_f32_dpp v90, v57, v57 row_ror:8 row_mask:0xf bank_mask:0x3
    s_nop 0
    v_add_f32_dpp v90, v58, v58 row_ror:8 row_mask:0xf bank_mask:0xc
    v_max_f32 v56, v56, v90
    s_waitcnt vmcnt(4)
    buffer_load_dwordx4 v[192:195], v1, s[16:19], s36 offen offset:2048 nt
    s_waitcnt vmcnt(4)
    buffer_load_dwordx4 v[196:199], v1, s[16:19], s36 offen offset:3072 nt
    s_waitcnt vmcnt(4)
    s_xor_b32 s36, s55, 0x4a000
    buffer_load_dwordx4 v[200:203], v1, s[16:19], s36 offen offset:0 nt
    v_mfma_f32_16x16x32_bf16 v[8:11], v[168:171], v[4:7], 0
    v_mfma_f32_16x16x32_bf16 v[12:15], v[172:175], v[4:7], 0
    v_mfma_f32_16x16x32_bf16 v[16:19], v[176:179], v[4:7], 0
    v_mfma_f32_16x16x32_bf16 v[20:23], v[180:183], v[4:7], 0
    s_nop 4
    s_waitcnt vmcnt(4)
    buffer_load_dwordx4 v[204:207], v1, s[16:19], s36 offen offset:1024 nt
    s_nop 2
    v_add_f32_dpp v57, v9, v8 row_ror:12 row_mask:0xf bank_mask:0x1
    v_add_f32_dpp v57, v11, v10 row_ror:12 row_mask:0xf bank_mask:0x4
    v_add_f32_dpp v57, v14, v13 row_ror:12 row_mask:0xf bank_mask:0x2
    v_add_f32_dpp v57, v12, v15 row_ror:12 row_mask:0xf bank_mask:0x8
    v_add_f32_dpp v58, v17, v16 row_ror:12 row_mask:0xf bank_mask:0x1
    v_add_f32_dpp v58, v19, v18 row_ror:12 row_mask:0xf bank_mask:0x4
    v_add_f32_dpp v58, v22, v21 row_ror:12 row_mask:0xf bank_mask:0x2
    v_add_f32_dpp v58, v20, v23 row_ror:12 row_mask:0xf bank_mask:0x8
    v_add_f32_dpp v91, v57, v57 row_ror:8 row_mask:0xf bank_mask:0x3
    s_nop 0
    v_add_f32_dpp v91, v58, v58 row_ror:8 row_mask:0xf bank_mask:0xc
    v_max_f32 v56, v56, v91
    s_waitcnt vmcnt(4)
    buffer_load_dwordx4 v[208:211], v1, s[16:19], s36 offen offset:2048 nt
    s_waitcnt vmcnt(4)
    buffer_load_dwordx4 v[212:215], v1, s[16:19], s36 offen offset:3072 nt
    s_waitcnt vmcnt(4)
    s_xor_b32 s36, s55, 0x50000
    buffer_load_dwordx4 v[120:123], v1, s[16:19], s36 offen offset:0 nt
    v_mfma_f32_16x16x32_bf16 v[8:11], v[184:187], v[4:7], 0
    v_mfma_f32_16x16x32_bf16 v[12:15], v[188:191], v[4:7], 0
    v_mfma_f32_16x16x32_bf16 v[16:19], v[192:195], v[4:7], 0
    v_mfma_f32_16x16x32_bf16 v[20:23], v[196:199], v[4:7], 0
    s_nop 4
    s_waitcnt vmcnt(4)
    buffer_load_dwordx4 v[124:127], v1, s[16:19], s36 offen offset:1024 nt
    s_nop 2
    v_add_f32_dpp v57, v9, v8 row_ror:12 row_mask:0xf bank_mask:0x1
    v_add_f32_dpp v57, v11, v10 row_ror:12 row_mask:0xf bank_mask:0x4
    v_add_f32_dpp v57, v14, v13 row_ror:12 row_mask:0xf bank_mask:0x2
    v_add_f32_dpp v57, v12, v15 row_ror:12 row_mask:0xf bank_mask:0x8
    v_add_f32_dpp v58, v17, v16 row_ror:12 row_mask:0xf bank_mask:0x1
    v_add_f32_dpp v58, v19, v18 row_ror:12 row_mask:0xf bank_mask:0x4
    v_add_f32_dpp v58, v22, v21 row_ror:12 row_mask:0xf bank_mask:0x2
    v_add_f32_dpp v58, v20, v23 row_ror:12 row_mask:0xf bank_mask:0x8
    v_add_f32_dpp v92, v57, v57 row_ror:8 row_mask:0xf bank_mask:0x3
    s_nop 0
    v_add_f32_dpp v92, v58, v58 row_ror:8 row_mask:0xf bank_mask:0xc
    v_max_f32 v56, v56, v92
    s_waitcnt vmcnt(4)
    buffer_load_dwordx4 v[128:131], v1, s[16:19], s36 offen offset:2048 nt
    s_waitcnt vmcnt(4)
    buffer_load_dwordx4 v[132:135], v1, s[16:19], s36 offen offset:3072 nt
    s_waitcnt vmcnt(4)
    s_xor_b32 s36, s55, 0x5a000
    buffer_load_dwordx4 v[136:139], v1, s[16:19], s36 offen offset:0 nt
    v_mfma_f32_16x16x32_bf16 v[8:11], v[200:203], v[4:7], 0
    v_mfma_f32_16x16x32_bf16 v[12:15], v[204:207], v[4:7], 0
    v_mfma_f32_16x16x32_bf16 v[16:19], v[208:211], v[4:7], 0
    v_mfma_f32_16x16x32_bf16 v[20:23], v[212:215], v[4:7], 0
    s_nop 4
    s_waitcnt vmcnt(4)
    buffer_load_dwordx4 v[140:143], v1, s[16:19], s36 offen offset:1024 nt
    s_nop 2
    v_add_f32_dpp v57, v9, v8 row_ror:12 row_mask:0xf bank_mask:0x1
    v_add_f32_dpp v57, v11, v10 row_ror:12 row_mask:0xf bank_mask:0x4
    v_add_f32_dpp v57, v14, v13 row_ror:12 row_mask:0xf bank_mask:0x2
    v_add_f32_dpp v57, v12, v15 row_ror:12 row_mask:0xf bank_mask:0x8
    v_add_f32_dpp v58, v17, v16 row_ror:12 row_mask:0xf bank_mask:0x1
    v_add_f32_dpp v58, v19, v18 row_ror:12 row_mask:0xf bank_mask:0x4
    v_add_f32_dpp v58, v22, v21 row_ror:12 row_mask:0xf bank_mask:0x2
    v_add_f32_dpp v58, v20, v23 row_ror:12 row_mask:0xf bank_mask:0x8
    v_add_f32_dpp v93, v57, v57 row_ror:8 row_mask:0xf bank_mask:0x3
    s_nop 0
    v_add_f32_dpp v93, v58, v58 row_ror:8 row_mask:0xf bank_mask:0xc
    v_max_f32 v56, v56, v93
    s_waitcnt vmcnt(4)
    buffer_load_dwordx4 v[144:147], v1, s[16:19], s36 offen offset:2048 nt
    s_waitcnt vmcnt(4)
    buffer_load_dwordx4 v[148:151], v1, s[16:19], s36 offen offset:3072 nt
    s_waitcnt vmcnt(4)
    s_xor_b32 s36, s55, 0xc000
    buffer_load_dwordx4 v[152:155], v1, s[16:19], s36 offen offset:0 nt
    v_mfma_f32_16x16x32_bf16 v[8:11], v[120:123], v[4:7], 0
    v_mfma_f32_16x16x32_bf16 v[12:15], v[124:127], v[4:7], 0
    v_mfma_f32_16x16x32_bf16 v[16:19], v[128:131], v[4:7], 0
    v_mfma_f32_16x16x32_bf16 v[20:23], v[132:135], v[4:7], 0
    s_nop 4
    s_waitcnt vmcnt(4)
    buffer_load_dwordx4 v[156:159], v1, s[16:19], s36 offen offset:1024 nt
    s_nop 2
    v_add_f32_dpp v57, v9, v8 row_ror:12 row_mask:0xf bank_mask:0x1
    v_add_f32_dpp v57, v11, v10 row_ror:12 row_mask:0xf bank_mask:0x4
    v_add_f32_dpp v57, v14, v13 row_ror:12 row_mask:0xf bank_mask:0x2
    v_add_f32_dpp v57, v12, v15 row_ror:12 row_mask:0xf bank_mask:0x8
    v_add_f32_dpp v58, v17, v16 row_ror:12 row_mask:0xf bank_mask:0x1
    v_add_f32_dpp v58, v19, v18 row_ror:12 row_mask:0xf bank_mask:0x4
    v_add_f32_dpp v58, v22, v21 row_ror:12 row_mask:0xf bank_mask:0x2
    v_add_f32_dpp v58, v20, v23 row_ror:12 row_mask:0xf bank_mask:0x8
    v_add_f32_dpp v94, v57, v57 row_ror:8 row_mask:0xf bank_mask:0x3
    s_nop 0
    v_add_f32_dpp v94, v58, v58 row_ror:8 row_mask:0xf bank_mask:0xc
    v_max_f32 v56, v56, v94
    s_waitcnt vmcnt(4)
    buffer_load_dwordx4 v[160:163], v1, s[16:19], s36 offen offset:2048 nt
    s_waitcnt vmcnt(4)
    buffer_load_dwordx4 v[164:167], v1, s[16:19], s36 offen offset:3072 nt
    s_waitcnt vmcnt(4)
    s_xor_b32 s36, s55, 0x6000
    buffer_load_dwordx4 v[168:171], v1, s[16:19], s36 offen offset:0 nt
    v_mfma_f32_16x16x32_bf16 v[8:11], v[136:139], v[4:7], 0
    v_mfma_f32_16x16x32_bf16 v[12:15], v[140:143], v[4:7], 0
    v_mfma_f32_16x16x32_bf16 v[16:19], v[144:147], v[4:7], 0
    v_mfma_f32_16x16x32_bf16 v[20:23], v[148:151], v[4:7], 0
    s_nop 4
    s_waitcnt vmcnt(4)
    buffer_load_dwordx4 v[172:175], v1, s[16:19], s36 offen offset:1024 nt
    s_nop 2
    v_add_f32_dpp v57, v9, v8 row_ror:12 row_mask:0xf bank_mask:0x1
    v_add_f32_dpp v57, v11, v10 row_ror:12 row_mask:0xf bank_mask:0x4
    v_add_f32_dpp v57, v14, v13 row_ror:12 row_mask:0xf bank_mask:0x2
    v_add_f32_dpp v57, v12, v15 row_ror:12 row_mask:0xf bank_mask:0x8
    v_add_f32_dpp v58, v17, v16 row_ror:12 row_mask:0xf bank_mask:0x1
    v_add_f32_dpp v58, v19, v18 row_ror:12 row_mask:0xf bank_mask:0x4
    v_add_f32_dpp v58, v22, v21 row_ror:12 row_mask:0xf bank_mask:0x2
    v_add_f32_dpp v58, v20, v23 row_ror:12 row_mask:0xf bank_mask:0x8
    v_add_f32_dpp v95, v57, v57 row_ror:8 row_mask:0xf bank_mask:0x3
    s_nop 0
    v_add_f32_dpp v95, v58, v58 row_ror:8 row_mask:0xf bank_mask:0xc
    v_max_f32 v56, v56, v95
    s_waitcnt vmcnt(4)
    buffer_load_dwordx4 v[176:179], v1, s[16:19], s36 offen offset:2048 nt
    s_waitcnt vmcnt(4)
    buffer_load_dwordx4 v[180:183], v1, s[16:19], s36 offen offset:3072 nt
    s_waitcnt vmcnt(4)
    s_xor_b32 s36, s55, 0x1c000
    buffer_load_dwordx4 v[184:187], v1, s[16:19], s36 offen offset:0 nt
    v_mfma_f32_16x16x32_bf16 v[8:11], v[152:155], v[4:7], 0
    v_mfma_f32_16x16x32_bf16 v[12:15], v[156:159], v[4:7], 0
    v_mfma_f32_16x16x32_bf16 v[16:19], v[160:163], v[4:7], 0
    v_mfma_f32_16x16x32_bf16 v[20:23], v[164:167], v[4:7], 0
    s_nop 4
    s_waitcnt vmcnt(4)
    buffer_load_dwordx4 v[188:191], v1, s[16:19], s36 offen offset:1024 nt
    s_nop 2
    v_add_f32_dpp v57, v9, v8 row_ror:12 row_mask:0xf bank_mask:0x1
    v_add_f32_dpp v57, v11, v10 row_ror:12 row_mask:0xf bank_mask:0x4
    v_add_f32_dpp v57, v14, v13 row_ror:12 row_mask:0xf bank_mask:0x2
    v_add_f32_dpp v57, v12, v15 row_ror:12 row_mask:0xf bank_mask:0x8
    v_add_f32_dpp v58, v17, v16 row_ror:12 row_mask:0xf bank_mask:0x1
    v_add_f32_dpp v58, v19, v18 row_ror:12 row_mask:0xf bank_mask:0x4
    v_add_f32_dpp v58, v22, v21 row_ror:12 row_mask:0xf bank_mask:0x2
    v_add_f32_dpp v58, v20, v23 row_ror:12 row_mask:0xf bank_mask:0x8
    v_add_f32_dpp v96, v57, v57 row_ror:8 row_mask:0xf bank_mask:0x3
    s_nop 0
    v_add_f32_dpp v96, v58, v58 row_ror:8 row_mask:0xf bank_mask:0xc
    v_max_f32 v56, v56, v96
    s_waitcnt vmcnt(4)
    buffer_load_dwordx4 v[192:195], v1, s[16:19], s36 offen offset:2048 nt
    s_waitcnt vmcnt(4)
    buffer_load_dwordx4 v[196:199], v1, s[16:19], s36 offen offset:3072 nt
    s_waitcnt vmcnt(4)
    s_xor_b32 s36, s55, 0x16000
    buffer_load_dwordx4 v[200:203], v1, s[16:19], s36 offen offset:0 nt
    v_mfma_f32_16x16x32_bf16 v[8:11], v[168:171], v[4:7], 0
    v_mfma_f32_16x16x32_bf16 v[12:15], v[172:175], v[4:7], 0
    v_mfma_f32_16x16x32_bf16 v[16:19], v[176:179], v[4:7], 0
    v_mfma_f32_16x16x32_bf16 v[20:23], v[180:183], v[4:7], 0
    s_nop 4
    s_waitcnt vmcnt(4)
    buffer_load_dwordx4 v[204:207], v1, s[16:19], s36 offen offset:1024 nt
    s_nop 2
    v_add_f32_dpp v57, v9, v8 row_ror:12 row_mask:0xf bank_mask:0x1
    v_add_f32_dpp v57, v11, v10 row_ror:12 row_mask:0xf bank_mask:0x4
    v_add_f32_dpp v57, v14, v13 row_ror:12 row_mask:0xf bank_mask:0x2
    v_add_f32_dpp v57, v12, v15 row_ror:12 row_mask:0xf bank_mask:0x8
    v_add_f32_dpp v58, v17, v16 row_ror:12 row_mask:0xf bank_mask:0x1
    v_add_f32_dpp v58, v19, v18 row_ror:12 row_mask:0xf bank_mask:0x4
    v_add_f32_dpp v58, v22, v21 row_ror:12 row_mask:0xf bank_mask:0x2
    v_add_f32_dpp v58, v20, v23 row_ror:12 row_mask:0xf bank_mask:0x8
    v_add_f32_dpp v97, v57, v57 row_ror:8 row_mask:0xf bank_mask:0x3
    s_nop 0
    v_add_f32_dpp v97, v58, v58 row_ror:8 row_mask:0xf bank_mask:0xc
    v_max_f32 v56, v56, v97
    s_waitcnt vmcnt(4)
    buffer_load_dwordx4 v[208:211], v1, s[16:19], s36 offen offset:2048 nt
    s_waitcnt vmcnt(4)
    buffer_load_dwordx4 v[212:215], v1, s[16:19], s36 offen offset:3072 nt
    s_waitcnt vmcnt(4)
    s_xor_b32 s36, s55, 0x4c000
    buffer_load_dwordx4 v[120:123], v1, s[16:19], s36 offen offset:0 nt
    v_mfma_f32_16x16x32_bf16 v[8:11], v[184:187], v[4:7], 0
    v_mfma_f32_16x16x32_bf16 v[12:15], v[188:191], v[4:7], 0
    v_mfma_f32_16x16x32_bf16 v[16:19], v[192:195], v[4:7], 0
    v_mfma_f32_16x16x32_bf16 v[20:23], v[196:199], v[4:7], 0
    s_nop 4
    s_waitcnt vmcnt(4)
    buffer_load_dwordx4 v[124:127], v1, s[16:19], s36 offen offset:1024 nt
    s_nop 2
    v_add_f32_dpp v57, v9, v8 row_ror:12 row_mask:0xf bank_mask:0x1
    v_add_f32_dpp v57, v11, v10 row_ror:12 row_mask:0xf bank_mask:0x4
    v_add_f32_dpp v57, v14, v13 row_ror:12 row_mask:0xf bank_mask:0x2
    v_add_f32_dpp v57, v12, v15 row_ror:12 row_mask:0xf bank_mask:0x8
    v_add_f32_dpp v58, v17, v16 row_ror:12 row_mask:0xf bank_mask:0x1
    v_add_f32_dpp v58, v19, v18 row_ror:12 row_mask:0xf bank_mask:0x4
    v_add_f32_dpp v58, v22, v21 row_ror:12 row_mask:0xf bank_mask:0x2
    v_add_f32_dpp v58, v20, v23 row_ror:12 row_mask:0xf bank_mask:0x8
    v_add_f32_dpp v98, v57, v57 row_ror:8 row_mask:0xf bank_mask:0x3
    s_nop 0
    v_add_f32_dpp v98, v58, v58 row_ror:8 row_mask:0xf bank_mask:0xc
    v_max_f32 v56, v56, v98
    s_waitcnt vmcnt(4)
    buffer_load_dwordx4 v[128:131], v1, s[16:19], s36 offen offset:2048 nt
    s_waitcnt vmcnt(4)
    buffer_load_dwordx4 v[132:135], v1, s[16:19], s36 offen offset:3072 nt
    s_waitcnt vmcnt(4)
    s_xor_b32 s36, s55, 0x46000
    buffer_load_dwordx4 v[136:139], v1, s[16:19], s36 offen offset:0 nt
    v_mfma_f32_16x16x32_bf16 v[8:11], v[200:203], v[4:7], 0
    v_mfma_f32_16x16x32_bf16 v[12:15], v[204:207], v[4:7], 0
    v_mfma_f32_16x16x32_bf16 v[16:19], v[208:211], v[4:7], 0
    v_mfma_f32_16x16x32_bf16 v[20:23], v[212:215], v[4:7], 0
    s_nop 4
    s_waitcnt vmcnt(4)
    buffer_load_dwordx4 v[140:143], v1, s[16:19], s36 offen offset:1024 nt
    s_nop 2
    v_add_f32_dpp v57, v9, v8 row_ror:12 row_mask:0xf bank_mask:0x1
    v_add_f32_dpp v57, v11, v10 row_ror:12 row_mask:0xf bank_mask:0x4
    v_add_f32_dpp v57, v14, v13 row_ror:12 row_mask:0xf bank_mask:0x2
    v_add_f32_dpp v57, v12, v15 row_ror:12 row_mask:0xf bank_mask:0x8
    v_add_f32_dpp v58, v17, v16 row_ror:12 row_mask:0xf bank_mask:0x1
    v_add_f32_dpp v58, v19, v18 row_ror:12 row_mask:0xf bank_mask:0x4
    v_add_f32_dpp v58, v22, v21 row_ror:12 row_mask:0xf bank_mask:0x2
    v_add_f32_dpp v58, v20, v23 row_ror:12 row_mask:0xf bank_mask:0x8
    v_add_f32_dpp v99, v57, v57 row_ror:8 row_mask:0xf bank_mask:0x3
    s_nop 0
    v_add_f32_dpp v99, v58, v58 row_ror:8 row_mask:0xf bank_mask:0xc
    v_max_f32 v56, v56, v99
    s_waitcnt vmcnt(4)
    buffer_load_dwordx4 v[144:147], v1, s[16:19], s36 offen offset:2048 nt
    s_waitcnt vmcnt(4)
    buffer_load_dwordx4 v[148:151], v1, s[16:19], s36 offen offset:3072 nt
    s_waitcnt vmcnt(4)
    s_xor_b32 s36, s55, 0x5c000
    buffer_load_dwordx4 v[152:155], v1, s[16:19], s36 offen offset:0 nt
    v_mfma_f32_16x16x32_bf16 v[8:11], v[120:123], v[4:7], 0
    v_mfma_f32_16x16x32_bf16 v[12:15], v[124:127], v[4:7], 0
    v_mfma_f32_16x16x32_bf16 v[16:19], v[128:131], v[4:7], 0
    v_mfma_f32_16x16x32_bf16 v[20:23], v[132:135], v[4:7], 0
    s_nop 4
    s_waitcnt vmcnt(4)
    buffer_load_dwordx4 v[156:159], v1, s[16:19], s36 offen offset:1024 nt
    s_nop 2
    v_add_f32_dpp v57, v9, v8 row_ror:12 row_mask:0xf bank_mask:0x1
    v_add_f32_dpp v57, v11, v10 row_ror:12 row_mask:0xf bank_mask:0x4
    v_add_f32_dpp v57, v14, v13 row_ror:12 row_mask:0xf bank_mask:0x2
    v_add_f32_dpp v57, v12, v15 row_ror:12 row_mask:0xf bank_mask:0x8
    v_add_f32_dpp v58, v17, v16 row_ror:12 row_mask:0xf bank_mask:0x1
    v_add_f32_dpp v58, v19, v18 row_ror:12 row_mask:0xf bank_mask:0x4
    v_add_f32_dpp v58, v22, v21 row_ror:12 row_mask:0xf bank_mask:0x2
    v_add_f32_dpp v58, v20, v23 row_ror:12 row_mask:0xf bank_mask:0x8
    v_add_f32_dpp v100, v57, v57 row_ror:8 row_mask:0xf bank_mask:0x3
    s_nop 0
    v_add_f32_dpp v100, v58, v58 row_ror:8 row_mask:0xf bank_mask:0xc
    v_max_f32 v56, v56, v100
    s_waitcnt vmcnt(4)
    buffer_load_dwordx4 v[160:163], v1, s[16:19], s36 offen offset:2048 nt
    s_waitcnt vmcnt(4)
    buffer_load_dwordx4 v[164:167], v1, s[16:19], s36 offen offset:3072 nt
    s_waitcnt vmcnt(4)
    s_xor_b32 s36, s55, 0x56000
    buffer_load_dwordx4 v[168:171], v1, s[16:19], s36 offen offset:0 nt
    v_mfma_f32_16x16x32_bf16 v[8:11], v[136:139], v[4:7], 0
    v_mfma_f32_16x16x32_bf16 v[12:15], v[140:143], v[4:7], 0
    v_mfma_f32_16x16x32_bf16 v[16:19], v[144:147], v[4:7], 0
    v_mfma_f32_16x16x32_bf16 v[20:23], v[148:151], v[4:7], 0
    s_nop 4
    s_waitcnt vmcnt(4)
    buffer_load_dwordx4 v[172:175], v1, s[16:19], s36 offen offset:1024 nt
    s_nop 2
    v_add_f32_dpp v57, v9, v8 row_ror:12 row_mask:0xf bank_mask:0x1
    v_add_f32_dpp v57, v11, v10 row_ror:12 row_mask:0xf bank_mask:0x4
    v_add_f32_dpp v57, v14, v13 row_ror:12 row_mask:0xf bank_mask:0x2
    v_add_f32_dpp v57, v12, v15 row_ror:12 row_mask:0xf bank_mask:0x8
    v_add_f32_dpp v58, v17, v16 row_ror:12 row_mask:0xf bank_mask:0x1
    v_add_f32_dpp v58, v19, v18 row_ror:12 row_mask:0xf bank_mask:0x4
    v_add_f32_dpp v58, v22, v21 row_ror:12 row_mask:0xf bank_mask:0x2
    v_add_f32_dpp v58, v20, v23 row_ror:12 row_mask:0xf bank_mask:0x8
    v_add_f32_dpp v101, v57, v57 row_ror:8 row_mask:0xf bank_mask:0x3
    s_nop 0
    v_add_f32_dpp v101, v58, v58 row_ror:8 row_mask:0xf bank_mask:0xc
    v_max_f32 v56, v56, v101
    s_waitcnt vmcnt(4)
    buffer_load_dwordx4 v[176:179], v1, s[16:19], s36 offen offset:2048 nt
    s_waitcnt vmcnt(4)
    buffer_load_dwordx4 v[180:183], v1, s[16:19], s36 offen offset:3072 nt
    s_waitcnt vmcnt(4)
    s_xor_b32 s36, s55, 0x20000
    buffer_load_dwordx4 v[184:187], v1, s[16:19], s36 offen offset:0 nt
    v_mfma_f32_16x16x32_bf16 v[8:11], v[152:155], v[4:7], 0
    v_mfma_f32_16x16x32_bf16 v[12:15], v[156:159], v[4:7], 0
    v_mfma_f32_16x16x32_bf16 v[16:19], v[160:163], v[4:7], 0
    v_mfma_f32_16x16x32_bf16 v[20:23], v[164:167], v[4:7], 0
    s_nop 4
    s_waitcnt vmcnt(4)
    buffer_load_dwordx4 v[188:191], v1, s[16:19], s36 offen offset:1024 nt
    s_nop 2
    v_add_f32_dpp v57, v9, v8 row_ror:12 row_mask:0xf bank_mask:0x1
    v_add_f32_dpp v57, v11, v10 row_ror:12 row_mask:0xf bank_mask:0x4
    v_add_f32_dpp v57, v14, v13 row_ror:12 row_mask:0xf bank_mask:0x2
    v_add_f32_dpp v57, v12, v15 row_ror:12 row_mask:0xf bank_mask:0x8
    v_add_f32_dpp v58, v17, v16 row_ror:12 row_mask:0xf bank_mask:0x1
    v_add_f32_dpp v58, v19, v18 row_ror:12 row_mask:0xf bank_mask:0x4
    v_add_f32_dpp v58, v22, v21 row_ror:12 row_mask:0xf bank_mask:0x2
    v_add_f32_dpp v58, v20, v23 row_ror:12 row_mask:0xf bank_mask:0x8
    v_add_f32_dpp v102, v57, v57 row_ror:8 row_mask:0xf bank_mask:0x3
    s_nop 0
    v_add_f32_dpp v102, v58, v58 row_ror:8 row_mask:0xf bank_mask:0xc
    v_max_f32 v56, v56, v102
    s_waitcnt vmcnt(4)
    buffer_load_dwordx4 v[192:195], v1, s[16:19], s36 offen offset:2048 nt
    s_waitcnt vmcnt(4)
    buffer_load_dwordx4 v[196:199], v1, s[16:19], s36 offen offset:3072 nt
    s_waitcnt vmcnt(4)
    s_xor_b32 s36, s55, 0x2a000
    buffer_load_dwordx4 v[200:203], v1, s[16:19], s36 offen offset:0 nt
    v_mfma_f32_16x16x32_bf16 v[8:11], v[168:171], v[4:7], 0
    v_mfma_f32_16x16x32_bf16 v[12:15], v[172:175], v[4:7], 0
    v_mfma_f32_16x16x32_bf16 v[16:19], v[176:179], v[4:7], 0
    v_mfma_f32_16x16x32_bf16 v[20:23], v[180:183], v[4:7], 0
    s_nop 4
    s_waitcnt vmcnt(4)
    buffer_load_dwordx4 v[204:207], v1, s[16:19], s36 offen offset:1024 nt
    s_nop 2
    v_add_f32_dpp v57, v9, v8 row_ror:12 row_mask:0xf bank_mask:0x1
    v_add_f32_dpp v57, v11, v10 row_ror:12 row_mask:0xf bank_mask:0x4
    v_add_f32_dpp v57, v14, v13 row_ror:12 row_mask:0xf bank_mask:0x2
    v_add_f32_dpp v57, v12, v15 row_ror:12 row_mask:0xf bank_mask:0x8
    v_add_f32_dpp v58, v17, v16 row_ror:12 row_mask:0xf bank_mask:0x1
    v_add_f32_dpp v58, v19, v18 row_ror:12 row_mask:0xf bank_mask:0x4
    v_add_f32_dpp v58, v22, v21 row_ror:12 row_mask:0xf bank_mask:0x2
    v_add_f32_dpp v58, v20, v23 row_ror:12 row_mask:0xf bank_mask:0x8
    v_add_f32_dpp v103, v57, v57 row_ror:8 row_mask:0xf bank_mask:0x3
    s_nop 0
    v_add_f32_dpp v103, v58, v58 row_ror:8 row_mask:0xf bank_mask:0xc
    v_max_f32 v56, v56, v103
    s_waitcnt vmcnt(4)
    buffer_load_dwordx4 v[208:211], v1, s[16:19], s36 offen offset:2048 nt
    s_waitcnt vmcnt(4)
    buffer_load_dwordx4 v[212:215], v1, s[16:19], s36 offen offset:3072 nt
    s_waitcnt vmcnt(4)
    s_xor_b32 s36, s55, 0x30000
    buffer_load_dwordx4 v[120:123], v1, s[16:19], s36 offen offset:0 nt
    v_mfma_f32_16x16x32_bf16 v[8:11], v[184:187], v[4:7], 0
    v_mfma_f32_16x16x32_bf16 v[12:15], v[188:191], v[4:7], 0
    v_mfma_f32_16x16x32_bf16 v[16:19], v[192:195], v[4:7], 0
    v_mfma_f32_16x16x32_bf16 v[20:23], v[196:199], v[4:7], 0
    s_nop 4
    s_waitcnt vmcnt(4)
    buffer_load_dwordx4 v[124:127], v1, s[16:19], s36 offen offset:1024 nt
    s_nop 2
    v_add_f32_dpp v57, v9, v8 row_ror:12 row_mask:0xf bank_mask:0x1
    v_add_f32_dpp v57, v11, v10 row_ror:12 row_mask:0xf bank_mask:0x4
    v_add_f32_dpp v57, v14, v13 row_ror:12 row_mask:0xf bank_mask:0x2
    v_add_f32_dpp v57, v12, v15 row_ror:12 row_mask:0xf bank_mask:0x8
    v_add_f32_dpp v58, v17, v16 row_ror:12 row_mask:0xf bank_mask:0x1
    v_add_f32_dpp v58, v19, v18 row_ror:12 row_mask:0xf bank_mask:0x4
    v_add_f32_dpp v58, v22, v21 row_ror:12 row_mask:0xf bank_mask:0x2
    v_add_f32_dpp v58, v20, v23 row_ror:12 row_mask:0xf bank_mask:0x8
    v_add_f32_dpp v104, v57, v57 row_ror:8 row_mask:0xf bank_mask:0x3
    s_nop 0
    v_add_f32_dpp v104, v58, v58 row_ror:8 row_mask:0xf bank_mask:0xc
    v_max_f32 v56, v56, v104
    s_waitcnt vmcnt(4)
    buffer_load_dwordx4 v[128:131], v1, s[16:19], s36 offen offset:2048 nt
    s_waitcnt vmcnt(4)
    buffer_load_dwordx4 v[132:135], v1, s[16:19], s36 offen offset:3072 nt
    s_waitcnt vmcnt(4)
    s_xor_b32 s36, s55, 0x3a000
    buffer_load_dwordx4 v[136:139], v1, s[16:19], s36 offen offset:0 nt
    v_mfma_f32_16x16x32_bf16 v[8:11], v[200:203], v[4:7], 0
    v_mfma_f32_16x16x32_bf16 v[12:15], v[204:207], v[4:7], 0
    v_mfma_f32_16x16x32_bf16 v[16:19], v[208:211], v[4:7], 0
    v_mfma_f32_16x16x32_bf16 v[20:23], v[212:215], v[4:7], 0
    s_nop 4
    s_waitcnt vmcnt(4)
    buffer_load_dwordx4 v[140:143], v1, s[16:19], s36 offen offset:1024 nt
    s_nop 2
    v_add_f32_dpp v57, v9, v8 row_ror:12 row_mask:0xf bank_mask:0x1
    v_add_f32_dpp v57, v11, v10 row_ror:12 row_mask:0xf bank_mask:0x4
    v_add_f32_dpp v57, v14, v13 row_ror:12 row_mask:0xf bank_mask:0x2
    v_add_f32_dpp v57, v12, v15 row_ror:12 row_mask:0xf bank_mask:0x8
    v_add_f32_dpp v58, v17, v16 row_ror:12 row_mask:0xf bank_mask:0x1
    v_add_f32_dpp v58, v19, v18 row_ror:12 row_mask:0xf bank_mask:0x4
    v_add_f32_dpp v58, v22, v21 row_ror:12 row_mask:0xf bank_mask:0x2
    v_add_f32_dpp v58, v20, v23 row_ror:12 row_mask:0xf bank_mask:0x8
    v_add_f32_dpp v105, v57, v57 row_ror:8 row_mask:0xf bank_mask:0x3
    s_nop 0
    v_add_f32_dpp v105, v58, v58 row_ror:8 row_mask:0xf bank_mask:0xc
    v_max_f32 v56, v56, v105
    s_waitcnt vmcnt(4)
    buffer_load_dwordx4 v[144:147], v1, s[16:19], s36 offen offset:2048 nt
    s_waitcnt vmcnt(4)
    buffer_load_dwordx4 v[148:151], v1, s[16:19], s36 offen offset:3072 nt
    s_waitcnt vmcnt(4)
    s_xor_b32 s36, s55, 0x60000
    buffer_load_dwordx4 v[152:155], v1, s[16:19], s36 offen offset:0 nt
    v_mfma_f32_16x16x32_bf16 v[8:11], v[120:123], v[4:7], 0
    v_mfma_f32_16x16x32_bf16 v[12:15], v[124:127], v[4:7], 0
    v_mfma_f32_16x16x32_bf16 v[16:19], v[128:131], v[4:7], 0
    v_mfma_f32_16x16x32_bf16 v[20:23], v[132:135], v[4:7], 0
    s_nop 4
    s_waitcnt vmcnt(4)
    buffer_load_dwordx4 v[156:159], v1, s[16:19], s36 offen offset:1024 nt
    s_nop 2
    v_add_f32_dpp v57, v9, v8 row_ror:12 row_mask:0xf bank_mask:0x1
    v_add_f32_dpp v57, v11, v10 row_ror:12 row_mask:0xf bank_mask:0x4
    v_add_f32_dpp v57, v14, v13 row_ror:12 row_mask:0xf bank_mask:0x2
    v_add_f32_dpp v57, v12, v15 row_ror:12 row_mask:0xf bank_mask:0x8
    v_add_f32_dpp v58, v17, v16 row_ror:12 row_mask:0xf bank_mask:0x1
    v_add_f32_dpp v58, v19, v18 row_ror:12 row_mask:0xf bank_mask:0x4
    v_add_f32_dpp v58, v22, v21 row_ror:12 row_mask:0xf bank_mask:0x2
    v_add_f32_dpp v58, v20, v23 row_ror:12 row_mask:0xf bank_mask:0x8
    v_add_f32_dpp v106, v57, v57 row_ror:8 row_mask:0xf bank_mask:0x3
    s_nop 0
    v_add_f32_dpp v106, v58, v58 row_ror:8 row_mask:0xf bank_mask:0xc
    v_max_f32 v56, v56, v106
    s_waitcnt vmcnt(4)
    buffer_load_dwordx4 v[160:163], v1, s[16:19], s36 offen offset:2048 nt
    s_waitcnt vmcnt(4)
    buffer_load_dwordx4 v[164:167], v1, s[16:19], s36 offen offset:3072 nt
    s_waitcnt vmcnt(4)
    s_xor_b32 s36, s55, 0x6a000
    buffer_load_dwordx4 v[168:171], v1, s[16:19], s36 offen offset:0 nt
    v_mfma_f32_16x16x32_bf16 v[8:11], v[136:139], v[4:7], 0
    v_mfma_f32_16x16x32_bf16 v[12:15], v[140:143], v[4:7], 0
    v_mfma_f32_16x16x32_bf16 v[16:19], v[144:147], v[4:7], 0
    v_mfma_f32_16x16x32_bf16 v[20:23], v[148:151], v[4:7], 0
    s_nop 4
    s_waitcnt vmcnt(4)
    buffer_load_dwordx4 v[172:175], v1, s[16:19], s36 offen offset:1024 nt
    s_nop 2
    v_add_f32_dpp v57, v9, v8 row_ror:12 row_mask:0xf bank_mask:0x1
    v_add_f32_dpp v57, v11, v10 row_ror:12 row_mask:0xf bank_mask:0x4
    v_add_f32_dpp v57, v14, v13 row_ror:12 row_mask:0xf bank_mask:0x2
    v_add_f32_dpp v57, v12, v15 row_ror:12 row_mask:0xf bank_mask:0x8
    v_add_f32_dpp v58, v17, v16 row_ror:12 row_mask:0xf bank_mask:0x1
    v_add_f32_dpp v58, v19, v18 row_ror:12 row_mask:0xf bank_mask:0x4
    v_add_f32_dpp v58, v22, v21 row_ror:12 row_mask:0xf bank_mask:0x2
    v_add_f32_dpp v58, v20, v23 row_ror:12 row_mask:0xf bank_mask:0x8
    v_add_f32_dpp v107, v57, v57 row_ror:8 row_mask:0xf bank_mask:0x3
    s_nop 0
    v_add_f32_dpp v107, v58, v58 row_ror:8 row_mask:0xf bank_mask:0xc
    v_max_f32 v56, v56, v107
    s_waitcnt vmcnt(4)
    buffer_load_dwordx4 v[176:179], v1, s[16:19], s36 offen offset:2048 nt
    s_waitcnt vmcnt(4)
    buffer_load_dwordx4 v[180:183], v1, s[16:19], s36 offen offset:3072 nt
    s_waitcnt vmcnt(4)
    s_xor_b32 s36, s55, 0x70000
    buffer_load_dwordx4 v[184:187], v1, s[16:19], s36 offen offset:0 nt
    v_mfma_f32_16x16x32_bf16 v[8:11], v[152:155], v[4:7], 0
    v_mfma_f32_16x16x32_bf16 v[12:15], v[156:159], v[4:7], 0
    v_mfma_f32_16x16x32_bf16 v[16:19], v[160:163], v[4:7], 0
    v_mfma_f32_16x16x32_bf16 v[20:23], v[164:167], v[4:7], 0
    s_nop 4
    s_waitcnt vmcnt(4)
    buffer_load_dwordx4 v[188:191], v1, s[16:19], s36 offen offset:1024 nt
    s_nop 2
    v_add_f32_dpp v57, v9, v8 row_ror:12 row_mask:0xf bank_mask:0x1
    v_add_f32_dpp v57, v11, v10 row_ror:12 row_mask:0xf bank_mask:0x4
    v_add_f32_dpp v57, v14, v13 row_ror:12 row_mask:0xf bank_mask:0x2
    v_add_f32_dpp v57, v12, v15 row_ror:12 row_mask:0xf bank_mask:0x8
    v_add_f32_dpp v58, v17, v16 row_ror:12 row_mask:0xf bank_mask:0x1
    v_add_f32_dpp v58, v19, v18 row_ror:12 row_mask:0xf bank_mask:0x4
    v_add_f32_dpp v58, v22, v21 row_ror:12 row_mask:0xf bank_mask:0x2
    v_add_f32_dpp v58, v20, v23 row_ror:12 row_mask:0xf bank_mask:0x8
    v_add_f32_dpp v108, v57, v57 row_ror:8 row_mask:0xf bank_mask:0x3
    s_nop 0
    v_add_f32_dpp v108, v58, v58 row_ror:8 row_mask:0xf bank_mask:0xc
    v_max_f32 v56, v56, v108
    s_waitcnt vmcnt(4)
    buffer_load_dwordx4 v[192:195], v1, s[16:19], s36 offen offset:2048 nt
    s_waitcnt vmcnt(4)
    buffer_load_dwordx4 v[196:199], v1, s[16:19], s36 offen offset:3072 nt
    s_waitcnt vmcnt(4)
    s_xor_b32 s36, s55, 0x7a000
    buffer_load_dwordx4 v[200:203], v1, s[16:19], s36 offen offset:0 nt
    v_mfma_f32_16x16x32_bf16 v[8:11], v[168:171], v[4:7], 0
    v_mfma_f32_16x16x32_bf16 v[12:15], v[172:175], v[4:7], 0
    v_mfma_f32_16x16x32_bf16 v[16:19], v[176:179], v[4:7], 0
    v_mfma_f32_16x16x32_bf16 v[20:23], v[180:183], v[4:7], 0
    s_nop 4
    s_waitcnt vmcnt(4)
    buffer_load_dwordx4 v[204:207], v1, s[16:19], s36 offen offset:1024 nt
    s_nop 2
    v_add_f32_dpp v57, v9, v8 row_ror:12 row_mask:0xf bank_mask:0x1
    v_add_f32_dpp v57, v11, v10 row_ror:12 row_mask:0xf bank_mask:0x4
    v_add_f32_dpp v57, v14, v13 row_ror:12 row_mask:0xf bank_mask:0x2
    v_add_f32_dpp v57, v12, v15 row_ror:12 row_mask:0xf bank_mask:0x8
    v_add_f32_dpp v58, v17, v16 row_ror:12 row_mask:0xf bank_mask:0x1
    v_add_f32_dpp v58, v19, v18 row_ror:12 row_mask:0xf bank_mask:0x4
    v_add_f32_dpp v58, v22, v21 row_ror:12 row_mask:0xf bank_mask:0x2
    v_add_f32_dpp v58, v20, v23 row_ror:12 row_mask:0xf bank_mask:0x8
    v_add_f32_dpp v109, v57, v57 row_ror:8 row_mask:0xf bank_mask:0x3
    s_nop 0
    v_add_f32_dpp v109, v58, v58 row_ror:8 row_mask:0xf bank_mask:0xc
    v_max_f32 v56, v56, v109
    s_waitcnt vmcnt(4)
    buffer_load_dwordx4 v[208:211], v1, s[16:19], s36 offen offset:2048 nt
    s_waitcnt vmcnt(4)
    buffer_load_dwordx4 v[212:215], v1, s[16:19], s36 offen offset:3072 nt
    s_waitcnt vmcnt(4)
    s_xor_b32 s36, s55, 0x2c000
    buffer_load_dwordx4 v[120:123], v1, s[16:19], s36 offen offset:0 nt
    v_mfma_f32_16x16x32_bf16 v[8:11], v[184:187], v[4:7], 0
    v_mfma_f32_16x16x32_bf16 v[12:15], v[188:191], v[4:7], 0
    v_mfma_f32_16x16x32_bf16 v[16:19], v[192:195], v[4:7], 0
    v_mfma_f32_16x16x32_bf16 v[20:23], v[196:199], v[4:7], 0
    s_nop 4
    s_waitcnt vmcnt(4)
    buffer_load_dwordx4 v[124:127], v1, s[16:19], s36 offen offset:1024 nt
    s_nop 2
    v_add_f32_dpp v57, v9, v8 row_ror:12 row_mask:0xf bank_mask:0x1
    v_add_f32_dpp v57, v11, v10 row_ror:12 row_mask:0xf bank_mask:0x4
    v_add_f32_dpp v57, v14, v13 row_ror:12 row_mask:0xf bank_mask:0x2
    v_add_f32_dpp v57, v12, v15 row_ror:12 row_mask:0xf bank_mask:0x8
    v_add_f32_dpp v58, v17, v16 row_ror:12 row_mask:0xf bank_mask:0x1
    v_add_f32_dpp v58, v19, v18 row_ror:12 row_mask:0xf bank_mask:0x4
    v_add_f32_dpp v58, v22, v21 row_ror:12 row_mask:0xf bank_mask:0x2
    v_add_f32_dpp v58, v20, v23 row_ror:12 row_mask:0xf bank_mask:0x8
    v_add_f32_dpp v110, v57, v57 row_ror:8 row_mask:0xf bank_mask:0x3
    s_nop 0
    v_add_f32_dpp v110, v58, v58 row_ror:8 row_mask:0xf bank_mask:0xc
    v_max_f32 v56, v56, v110
    s_waitcnt vmcnt(4)
    buffer_load_dwordx4 v[128:131], v1, s[16:19], s36 offen offset:2048 nt
    s_waitcnt vmcnt(4)
    buffer_load_dwordx4 v[132:135], v1, s[16:19], s36 offen offset:3072 nt
    s_waitcnt vmcnt(4)
    s_xor_b32 s36, s55, 0x26000
    buffer_load_dwordx4 v[136:139], v1, s[16:19], s36 offen offset:0 nt
    v_mfma_f32_16x16x32_bf16 v[8:11], v[200:203], v[4:7], 0
    v_mfma_f32_16x16x32_bf16 v[12:15], v[204:207], v[4:7], 0
    v_mfma_f32_16x16x32_bf16 v[16:19], v[208:211], v[4:7], 0
    v_mfma_f32_16x16x32_bf16 v[20:23], v[212:215], v[4:7], 0
    s_nop 4
    s_waitcnt vmcnt(4)
    buffer_load_dwordx4 v[140:143], v1, s[16:19], s36 offen offset:1024 nt
    s_nop 2
    v_add_f32_dpp v57, v9, v8 row_ror:12 row_mask:0xf bank_mask:0x1
    v_add_f32_dpp v57, v11, v10 row_ror:12 row_mask:0xf bank_mask:0x4
    v_add_f32_dpp v57, v14, v13 row_ror:12 row_mask:0xf bank_mask:0x2
    v_add_f32_dpp v57, v12, v15 row_ror:12 row_mask:0xf bank_mask:0x8
    v_add_f32_dpp v58, v17, v16 row_ror:12 row_mask:0xf bank_mask:0x1
    v_add_f32_dpp v58, v19, v18 row_ror:12 row_mask:0xf bank_mask:0x4
    v_add_f32_dpp v58, v22, v21 row_ror:12 row_mask:0xf bank_mask:0x2
    v_add_f32_dpp v58, v20, v23 row_ror:12 row_mask:0xf bank_mask:0x8
    v_add_f32_dpp v111, v57, v57 row_ror:8 row_mask:0xf bank_mask:0x3
    s_nop 0
    v_add_f32_dpp v111, v58, v58 row_ror:8 row_mask:0xf bank_mask:0xc
    v_max_f32 v56, v56, v111
    s_waitcnt vmcnt(4)
    buffer_load_dwordx4 v[144:147], v1, s[16:19], s36 offen offset:2048 nt
    s_waitcnt vmcnt(4)
    buffer_load_dwordx4 v[148:151], v1, s[16:19], s36 offen offset:3072 nt
    s_waitcnt vmcnt(4)
    s_xor_b32 s36, s55, 0x3c000
    buffer_load_dwordx4 v[152:155], v1, s[16:19], s36 offen offset:0 nt
    v_mfma_f32_16x16x32_bf16 v[8:11], v[120:123], v[4:7], 0
    v_mfma_f32_16x16x32_bf16 v[12:15], v[124:127], v[4:7], 0
    v_mfma_f32_16x16x32_bf16 v[16:19], v[128:131], v[4:7], 0
    v_mfma_f32_16x16x32_bf16 v[20:23], v[132:135], v[4:7], 0
    s_nop 4
    s_waitcnt vmcnt(4)
    buffer_load_dwordx4 v[156:159], v1, s[16:19], s36 offen offset:1024 nt
    s_nop 2
    v_add_f32_dpp v57, v9, v8 row_ror:12 row_mask:0xf bank_mask:0x1
    v_add_f32_dpp v57, v11, v10 row_ror:12 row_mask:0xf bank_mask:0x4
    v_add_f32_dpp v57, v14, v13 row_ror:12 row_mask:0xf bank_mask:0x2
    v_add_f32_dpp v57, v12, v15 row_ror:12 row_mask:0xf bank_mask:0x8
    v_add_f32_dpp v58, v17, v16 row_ror:12 row_mask:0xf bank_mask:0x1
    v_add_f32_dpp v58, v19, v18 row_ror:12 row_mask:0xf bank_mask:0x4
    v_add_f32_dpp v58, v22, v21 row_ror:12 row_mask:0xf bank_mask:0x2
    v_add_f32_dpp v58, v20, v23 row_ror:12 row_mask:0xf bank_mask:0x8
    v_add_f32_dpp v112, v57, v57 row_ror:8 row_mask:0xf bank_mask:0x3
    s_nop 0
    v_add_f32_dpp v112, v58, v58 row_ror:8 row_mask:0xf bank_mask:0xc
    v_max_f32 v56, v56, v112
    s_waitcnt vmcnt(4)
    buffer_load_dwordx4 v[160:163], v1, s[16:19], s36 offen offset:2048 nt
    s_waitcnt vmcnt(4)
    buffer_load_dwordx4 v[164:167], v1, s[16:19], s36 offen offset:3072 nt
    s_waitcnt vmcnt(4)
    s_xor_b32 s36, s55, 0x36000
    buffer_load_dwordx4 v[168:171], v1, s[16:19], s36 offen offset:0 nt
    v_mfma_f32_16x16x32_bf16 v[8:11], v[136:139], v[4:7], 0
    v_mfma_f32_16x16x32_bf16 v[12:15], v[140:143], v[4:7], 0
    v_mfma_f32_16x16x32_bf16 v[16:19], v[144:147], v[4:7], 0
    v_mfma_f32_16x16x32_bf16 v[20:23], v[148:151], v[4:7], 0
    s_nop 4
    s_waitcnt vmcnt(4)
    buffer_load_dwordx4 v[172:175], v1, s[16:19], s36 offen offset:1024 nt
    s_nop 2
    v_add_f32_dpp v57, v9, v8 row_ror:12 row_mask:0xf bank_mask:0x1
    v_add_f32_dpp v57, v11, v10 row_ror:12 row_mask:0xf bank_mask:0x4
    v_add_f32_dpp v57, v14, v13 row_ror:12 row_mask:0xf bank_mask:0x2
    v_add_f32_dpp v57, v12, v15 row_ror:12 row_mask:0xf bank_mask:0x8
    v_add_f32_dpp v58, v17, v16 row_ror:12 row_mask:0xf bank_mask:0x1
    v_add_f32_dpp v58, v19, v18 row_ror:12 row_mask:0xf bank_mask:0x4
    v_add_f32_dpp v58, v22, v21 row_ror:12 row_mask:0xf bank_mask:0x2
    v_add_f32_dpp v58, v20, v23 row_ror:12 row_mask:0xf bank_mask:0x8
    v_add_f32_dpp v113, v57, v57 row_ror:8 row_mask:0xf bank_mask:0x3
    s_nop 0
    v_add_f32_dpp v113, v58, v58 row_ror:8 row_mask:0xf bank_mask:0xc
    v_max_f32 v56, v56, v113
    s_waitcnt vmcnt(4)
    buffer_load_dwordx4 v[176:179], v1, s[16:19], s36 offen offset:2048 nt
    s_waitcnt vmcnt(4)
    buffer_load_dwordx4 v[180:183], v1, s[16:19], s36 offen offset:3072 nt
    s_waitcnt vmcnt(4)
    s_xor_b32 s36, s55, 0x6c000
    buffer_load_dwordx4 v[184:187], v1, s[16:19], s36 offen offset:0 nt
    v_mfma_f32_16x16x32_bf16 v[8:11], v[152:155], v[4:7], 0
    v_mfma_f32_16x16x32_bf16 v[12:15], v[156:159], v[4:7], 0
    v_mfma_f32_16x16x32_bf16 v[16:19], v[160:163], v[4:7], 0
    v_mfma_f32_16x16x32_bf16 v[20:23], v[164:167], v[4:7], 0
    s_nop 4
    s_waitcnt vmcnt(4)
    buffer_load_dwordx4 v[188:191], v1, s[16:19], s36 offen offset:1024 nt
    s_nop 2
    v_add_f32_dpp v57, v9, v8 row_ror:12 row_mask:0xf bank_mask:0x1
    v_add_f32_dpp v57, v11, v10 row_ror:12 row_mask:0xf bank_mask:0x4
    v_add_f32_dpp v57, v14, v13 row_ror:12 row_mask:0xf bank_mask:0x2
    v_add_f32_dpp v57, v12, v15 row_ror:12 row_mask:0xf bank_mask:0x8
    v_add_f32_dpp v58, v17, v16 row_ror:12 row_mask:0xf bank_mask:0x1
    v_add_f32_dpp v58, v19, v18 row_ror:12 row_mask:0xf bank_mask:0x4
    v_add_f32_dpp v58, v22, v21 row_ror:12 row_mask:0xf bank_mask:0x2
    v_add_f32_dpp v58, v20, v23 row_ror:12 row_mask:0xf bank_mask:0x8
    v_add_f32_dpp v114, v57, v57 row_ror:8 row_mask:0xf bank_mask:0x3
    s_nop 0
    v_add_f32_dpp v114, v58, v58 row_ror:8 row_mask:0xf bank_mask:0xc
    v_max_f32 v56, v56, v114
    s_waitcnt vmcnt(4)
    buffer_load_dwordx4 v[192:195], v1, s[16:19], s36 offen offset:2048 nt
    s_waitcnt vmcnt(4)
    buffer_load_dwordx4 v[196:199], v1, s[16:19], s36 offen offset:3072 nt
    s_waitcnt vmcnt(4)
    s_xor_b32 s36, s55, 0x66000
    buffer_load_dwordx4 v[200:203], v1, s[16:19], s36 offen offset:0 nt
    v_mfma_f32_16x16x32_bf16 v[8:11], v[168:171], v[4:7], 0
    v_mfma_f32_16x16x32_bf16 v[12:15], v[172:175], v[4:7], 0
    v_mfma_f32_16x16x32_bf16 v[16:19], v[176:179], v[4:7], 0
    v_mfma_f32_16x16x32_bf16 v[20:23], v[180:183], v[4:7], 0
    s_nop 4
    s_waitcnt vmcnt(4)
    buffer_load_dwordx4 v[204:207], v1, s[16:19], s36 offen offset:1024 nt
    s_nop 2
    v_add_f32_dpp v57, v9, v8 row_ror:12 row_mask:0xf bank_mask:0x1
    v_add_f32_dpp v57, v11, v10 row_ror:12 row_mask:0xf bank_mask:0x4
    v_add_f32_dpp v57, v14, v13 row_ror:12 row_mask:0xf bank_mask:0x2
    v_add_f32_dpp v57, v12, v15 row_ror:12 row_mask:0xf bank_mask:0x8
    v_add_f32_dpp v58, v17, v16 row_ror:12 row_mask:0xf bank_mask:0x1
    v_add_f32_dpp v58, v19, v18 row_ror:12 row_mask:0xf bank_mask:0x4
    v_add_f32_dpp v58, v22, v21 row_ror:12 row_mask:0xf bank_mask:0x2
    v_add_f32_dpp v58, v20, v23 row_ror:12 row_mask:0xf bank_mask:0x8
    v_add_f32_dpp v115, v57, v57 row_ror:8 row_mask:0xf bank_mask:0x3
    s_nop 0
    v_add_f32_dpp v115, v58, v58 row_ror:8 row_mask:0xf bank_mask:0xc
    v_max_f32 v56, v56, v115
    s_waitcnt vmcnt(4)
    buffer_load_dwordx4 v[208:211], v1, s[16:19], s36 offen offset:2048 nt
    s_waitcnt vmcnt(4)
    buffer_load_dwordx4 v[212:215], v1, s[16:19], s36 offen offset:3072 nt
    s_waitcnt vmcnt(4)
    s_xor_b32 s36, s55, 0x7c000
    buffer_load_dwordx4 v[120:123], v1, s[16:19], s36 offen offset:0 nt
    v_mfma_f32_16x16x32_bf16 v[8:11], v[184:187], v[4:7], 0
    v_mfma_f32_16x16x32_bf16 v[12:15], v[188:191], v[4:7], 0
    v_mfma_f32_16x16x32_bf16 v[16:19], v[192:195], v[4:7], 0
    v_mfma_f32_16x16x32_bf16 v[20:23], v[196:199], v[4:7], 0
    s_nop 4
    s_waitcnt vmcnt(4)
    buffer_load_dwordx4 v[124:127], v1, s[16:19], s36 offen offset:1024 nt
    s_nop 2
    v_add_f32_dpp v57, v9, v8 row_ror:12 row_mask:0xf bank_mask:0x1
    v_add_f32_dpp v57, v11, v10 row_ror:12 row_mask:0xf bank_mask:0x4
    v_add_f32_dpp v57, v14, v13 row_ror:12 row_mask:0xf bank_mask:0x2
    v_add_f32_dpp v57, v12, v15 row_ror:12 row_mask:0xf bank_mask:0x8
    v_add_f32_dpp v58, v17, v16 row_ror:12 row_mask:0xf bank_mask:0x1
    v_add_f32_dpp v58, v19, v18 row_ror:12 row_mask:0xf bank_mask:0x4
    v_add_f32_dpp v58, v22, v21 row_ror:12 row_mask:0xf bank_mask:0x2
    v_add_f32_dpp v58, v20, v23 row_ror:12 row_mask:0xf bank_mask:0x8
    v_add_f32_dpp v116, v57, v57 row_ror:8 row_mask:0xf bank_mask:0x3
    s_nop 0
    v_add_f32_dpp v116, v58, v58 row_ror:8 row_mask:0xf bank_mask:0xc
    v_max_f32 v56, v56, v116
    s_waitcnt vmcnt(4)
    buffer_load_dwordx4 v[128:131], v1, s[16:19], s36 offen offset:2048 nt
    s_waitcnt vmcnt(4)
    buffer_load_dwordx4 v[132:135], v1, s[16:19], s36 offen offset:3072 nt
    s_waitcnt vmcnt(4)
    s_xor_b32 s36, s55, 0x76000
    buffer_load_dwordx4 v[136:139], v1, s[16:19], s36 offen offset:0 nt
    v_mfma_f32_16x16x32_bf16 v[8:11], v[200:203], v[4:7], 0
    v_mfma_f32_16x16x32_bf16 v[12:15], v[204:207], v[4:7], 0
    v_mfma_f32_16x16x32_bf16 v[16:19], v[208:211], v[4:7], 0
    v_mfma_f32_16x16x32_bf16 v[20:23], v[212:215], v[4:7], 0
    s_nop 4
    s_waitcnt vmcnt(4)
    buffer_load_dwordx4 v[140:143], v1, s[16:19], s36 offen offset:1024 nt
    s_nop 2
    v_add_f32_dpp v57, v9, v8 row_ror:12 row_mask:0xf bank_mask:0x1
    v_add_f32_dpp v57, v11, v10 row_ror:12 row_mask:0xf bank_mask:0x4
    v_add_f32_dpp v57, v14, v13 row_ror:12 row_mask:0xf bank_mask:0x2
    v_add_f32_dpp v57, v12, v15 row_ror:12 row_mask:0xf bank_mask:0x8
    v_add_f32_dpp v58, v17, v16 row_ror:12 row_mask:0xf bank_mask:0x1
    v_add_f32_dpp v58, v19, v18 row_ror:12 row_mask:0xf bank_mask:0x4
    v_add_f32_dpp v58, v22, v21 row_ror:12 row_mask:0xf bank_mask:0x2
    v_add_f32_dpp v58, v20, v23 row_ror:12 row_mask:0xf bank_mask:0x8
    v_add_f32_dpp v117, v57, v57 row_ror:8 row_mask:0xf bank_mask:0x3
    s_nop 0
    v_add_f32_dpp v117, v58, v58 row_ror:8 row_mask:0xf bank_mask:0xc
    v_max_f32 v56, v56, v117
    s_waitcnt vmcnt(4)
    buffer_load_dwordx4 v[144:147], v1, s[16:19], s36 offen offset:2048 nt
    s_waitcnt vmcnt(4)
    buffer_load_dwordx4 v[148:151], v1, s[16:19], s36 offen offset:3072 nt
    s_waitcnt vmcnt(4)
    buffer_load_dwordx4 v[152:155], v2, s[20:23], s55 offen offset:0 nt
    v_mfma_f32_16x16x32_bf16 v[8:11], v[120:123], v[4:7], 0
    v_mfma_f32_16x16x32_bf16 v[12:15], v[124:127], v[4:7], 0
    v_mfma_f32_16x16x32_bf16 v[16:19], v[128:131], v[4:7], 0
    v_mfma_f32_16x16x32_bf16 v[20:23], v[132:135], v[4:7], 0
    s_nop 4
    s_waitcnt vmcnt(4)
    buffer_load_dwordx4 v[156:159], v2, s[20:23], s55 offen offset:1024 nt
    s_nop 2
    v_add_f32_dpp v57, v9, v8 row_ror:12 row_mask:0xf bank_mask:0x1
    v_add_f32_dpp v57, v11, v10 row_ror:12 row_mask:0xf bank_mask:0x4
    v_add_f32_dpp v57, v14, v13 row_ror:12 row_mask:0xf bank_mask:0x2
    v_add_f32_dpp v57, v12, v15 row_ror:12 row_mask:0xf bank_mask:0x8
    v_add_f32_dpp v58, v17, v16 row_ror:12 row_mask:0xf bank_mask:0x1
    v_add_f32_dpp v58, v19, v18 row_ror:12 row_mask:0xf bank_mask:0x4
    v_add_f32_dpp v58, v22, v21 row_ror:12 row_mask:0xf bank_mask:0x2
    v_add_f32_dpp v58, v20, v23 row_ror:12 row_mask:0xf bank_mask:0x8
    v_add_f32_dpp v118, v57, v57 row_ror:8 row_mask:0xf bank_mask:0x3
    s_nop 0
    v_add_f32_dpp v118, v58, v58 row_ror:8 row_mask:0xf bank_mask:0xc
    v_max_f32 v56, v56, v118
    s_waitcnt vmcnt(4)
    buffer_load_dwordx4 v[160:163], v2, s[20:23], s55 offen offset:2048 nt
    s_waitcnt vmcnt(4)
    buffer_load_dwordx4 v[164:167], v2, s[20:23], s55 offen offset:3072 nt
    s_waitcnt vmcnt(4)
    s_xor_b32 s37, s55, 0xa000
    buffer_load_dwordx4 v[168:171], v2, s[20:23], s37 offen offset:0 nt
    v_mfma_f32_16x16x32_bf16 v[8:11], v[136:139], v[4:7], 0
    v_mfma_f32_16x16x32_bf16 v[12:15], v[140:143], v[4:7], 0
    v_mfma_f32_16x16x32_bf16 v[16:19], v[144:147], v[4:7], 0
    v_mfma_f32_16x16x32_bf16 v[20:23], v[148:151], v[4:7], 0
    s_nop 4
    s_waitcnt vmcnt(4)
    buffer_load_dwordx4 v[172:175], v2, s[20:23], s37 offen offset:1024 nt
    s_nop 2
    v_add_f32_dpp v57, v9, v8 row_ror:12 row_mask:0xf bank_mask:0x1
    v_add_f32_dpp v57, v11, v10 row_ror:12 row_mask:0xf bank_mask:0x4
    v_add_f32_dpp v57, v14, v13 row_ror:12 row_mask:0xf bank_mask:0x2
    v_add_f32_dpp v57, v12, v15 row_ror:12 row_mask:0xf bank_mask:0x8
    v_add_f32_dpp v58, v17, v16 row_ror:12 row_mask:0xf bank_mask:0x1
    v_add_f32_dpp v58, v19, v18 row_ror:12 row_mask:0xf bank_mask:0x4
    v_add_f32_dpp v58, v22, v21 row_ror:12 row_mask:0xf bank_mask:0x2
    v_add_f32_dpp v58, v20, v23 row_ror:12 row_mask:0xf bank_mask:0x8
    v_add_f32_dpp v119, v57, v57 row_ror:8 row_mask:0xf bank_mask:0x3
    s_nop 0
    v_add_f32_dpp v119, v58, v58 row_ror:8 row_mask:0xf bank_mask:0xc
    v_max_f32 v56, v56, v119
    s_waitcnt vmcnt(4)
    buffer_load_dwordx4 v[176:179], v2, s[20:23], s37 offen offset:2048 nt
    s_nop 1
    v_max_f32_dpp v56, v56, v56 row_ror:4 row_mask:0xf bank_mask:0xf
    s_nop 1
    v_max_f32_dpp v56, v56, v56 row_ror:8 row_mask:0xf bank_mask:0xf
    v_mov_b32 v57, v56
    s_nop 1
    v_permlane16_swap_b32 v56, v57
    v_max_f32 v56, v56, v57
    v_mov_b32 v57, v56
    s_nop 1
    v_permlane32_swap_b32 v56, v57
    v_max_f32 v56, v56, v57
    v_and_b32 v58, 15, v3
    v_lshlrev_b32 v58, 2, v58
    s_lshl_b32 s41, s44, 4
    v_add_u32 v57, s41, v58
    v_mov_b32 v59, 1
    s_mov_b64 exec, 0xf
    ds_write_b32 v57, v56 offset:64
    s_mov_b64 exec, 1
    ds_add_u32 v64, v59 offset:4
    s_mov_b64 exec, -1
    v_mov_b32 v4, 0x3f803f80
    v_mov_b32 v5, 0x3f803f80
    v_mov_b32 v6, 0x3f803f80
    v_mov_b32 v7, 0x3f803f80
    s_waitcnt vmcnt(4)
    buffer_load_dwordx4 v[180:183], v2, s[20:23], s37 offen offset:3072 nt
    s_waitcnt vmcnt(4)
    s_xor_b32 s37, s55, 0x10000
    buffer_load_dwordx4 v[184:187], v2, s[20:23], s37 offen offset:0 nt
    s_waitcnt vmcnt(4)
    buffer_load_dwordx4 v[188:191], v2, s[20:23], s37 offen offset:1024 nt
    s_waitcnt vmcnt(4)
    buffer_load_dwordx4 v[192:195], v2, s[20:23], s37 offen offset:2048 nt
    s_waitcnt vmcnt(4)
    buffer_load_dwordx4 v[196:199], v2, s[20:23], s37 offen offset:3072 nt
    s_waitcnt vmcnt(4)
    s_xor_b32 s37, s55, 0x1a000
    buffer_load_dwordx4 v[200:203], v2, s[20:23], s37 offen offset:0 nt
    s_waitcnt vmcnt(4)
    buffer_load_dwordx4 v[204:207], v2, s[20:23], s37 offen offset:1024 nt
    s_waitcnt vmcnt(4)
    buffer_load_dwordx4 v[208:211], v2, s[20:23], s37 offen offset:2048 nt
    s_waitcnt vmcnt(4)
    buffer_load_dwordx4 v[212:215], v2, s[20:23], s37 offen offset:3072 nt
    s_waitcnt vmcnt(4)
    s_xor_b32 s37, s55, 0x40000
    buffer_load_dwordx4 v[120:123], v2, s[20:23], s37 offen offset:0 nt
    s_waitcnt vmcnt(4)
    buffer_load_dwordx4 v[124:127], v2, s[20:23], s37 offen offset:1024 nt
L_wmax:
    ds_read_b32 v59, v64 offset:4
    ds_read_b32 v56, v58 offset:64
    s_waitcnt lgkmcnt(0)
    v_readfirstlane_b32 s41, v59
    s_cmp_lg_u32 s41, 4
    s_cbranch_scc1 L_wmax
    v_max_f32_dpp v56, v56, v56 row_ror:4 row_mask:0xf bank_mask:0xf
    s_nop 1
    v_max_f32_dpp v56, v56, v56 row_ror:8 row_mask:0xf bank_mask:0xf
    v_mul_f32 v60, s38, v56
    s_waitcnt vmcnt(4)
    buffer_load_dwordx4 v[128:131], v2, s[20:23], s37 offen offset:2048 nt
    v_fma_f32 v61, v88, s38, -v60
    v_fma_f32 v62, v89, s38, -v60
    v_exp_f32 v61, v61
    v_exp_f32 v62, v62
    s_nop 0
    v_cvt_pk_bf16_f32 v44, v61, v62
    s_nop 1
    v_mov_b32_dpp v45, v44 row_ror:12 row_mask:0xf bank_mask:0xf
    v_mov_b32_dpp v46, v44 row_ror:8 row_mask:0xf bank_mask:0xf
    v_mov_b32_dpp v47, v44 row_ror:4 row_mask:0xf bank_mask:0xf
    s_nop 1
    v_mfma_f32_16x16x32_bf16 v[40:43], v[44:47], v[4:7], 0
    s_waitcnt vmcnt(4)
    buffer_load_dwordx4 v[132:135], v2, s[20:23], s37 offen offset:3072 nt
    v_perm_b32 v48, v168, v152, s39
    v_perm_b32 v49, v172, v156, s39
    v_perm_b32 v50, v176, v160, s39
    v_perm_b32 v51, v180, v164, s39
    v_perm_b32 v52, v168, v152, s40
    v_perm_b32 v53, v172, v156, s40
    v_perm_b32 v54, v176, v160, s40
    v_perm_b32 v55, v180, v164, s40
    v_mfma_f32_16x16x32_bf16 v[8:11], v[44:47], v[48:51], 0
    v_perm_b32 v48, v169, v153, s39
    v_perm_b32 v49, v173, v157, s39
    v_perm_b32 v50, v177, v161, s39
    v_perm_b32 v51, v181, v165, s39
    v_mfma_f32_16x16x32_bf16 v[12:15], v[44:47], v[52:55], 0
    v_perm_b32 v52, v169, v153, s40
    v_perm_b32 v53, v173, v157, s40
    v_perm_b32 v54, v177, v161, s40
    v_perm_b32 v55, v181, v165, s40
    v_mfma_f32_16x16x32_bf16 v[16:19], v[44:47], v[48:51], 0
    s_nop 0
    v_mfma_f32_16x16x32_bf16 v[20:23], v[44:47], v[52:55], 0
    s_waitcnt vmcnt(4)
    s_xor_b32 s37, s55, 0x4a000
    buffer_load_dwordx4 v[136:139], v2, s[20:23], s37 offen offset:0 nt
    v_perm_b32 v48, v170, v154, s39
    v_perm_b32 v49, v174, v158, s39
    v_perm_b32 v50, v178, v162, s39
    v_perm_b32 v51, v182, v166, s39
    v_perm_b32 v52, v170, v154, s40
    v_perm_b32 v53, v174, v158, s40
    v_perm_b32 v54, v178, v162, s40
    v_perm_b32 v55, v182, v166, s40
    v_mfma_f32_16x16x32_bf16 v[24:27], v[44:47], v[48:51], 0
    v_perm_b32 v48, v171, v155, s39
    v_perm_b32 v49, v175, v159, s39
    v_perm_b32 v50, v179, v163, s39
    v_perm_b32 v51, v183, v167, s39
    v_mfma_f32_16x16x32_bf16 v[28:31], v[44:47], v[52:55], 0
    v_perm_b32 v52, v171, v155, s40
    v_perm_b32 v53, v175, v159, s40
    v_perm_b32 v54, v179, v163, s40
    v_perm_b32 v55, v183, v167, s40
    v_mfma_f32_16x16x32_bf16 v[32:35], v[44:47], v[48:51], 0
    s_nop 0
    v_mfma_f32_16x16x32_bf16 v[36:39], v[44:47], v[52:55], 0
    s_waitcnt vmcnt(4)
    buffer_load_dwordx4 v[140:143], v2, s[20:23], s37 offen offset:1024 nt
    v_fma_f32 v61, v90, s38, -v60
    v_fma_f32 v62, v91, s38, -v60
    v_exp_f32 v61, v61
    v_exp_f32 v62, v62
    s_nop 0
    v_cvt_pk_bf16_f32 v44, v61, v62
    s_nop 1
    v_mov_b32_dpp v45, v44 row_ror:12 row_mask:0xf bank_mask:0xf
    v_mov_b32_dpp v46, v44 row_ror:8 row_mask:0xf bank_mask:0xf
    v_mov_b32_dpp v47, v44 row_ror:4 row_mask:0xf bank_mask:0xf
    s_nop 1
    v_mfma_f32_16x16x32_bf16 v[40:43], v[44:47], v[4:7], v[40:43]
    s_waitcnt vmcnt(4)
    buffer_load_dwordx4 v[144:147], v2, s[20:23], s37 offen offset:2048 nt
    v_perm_b32 v48, v200, v184, s39
    v_perm_b32 v49, v204, v188, s39
    v_perm_b32 v50, v208, v192, s39
    v_perm_b32 v51, v212, v196, s39
    v_perm_b32 v52, v200, v184, s40
    v_perm_b32 v53, v204, v188, s40
    v_perm_b32 v54, v208, v192, s40
    v_perm_b32 v55, v212, v196, s40
    v_mfma_f32_16x16x32_bf16 v[8:11], v[44:47], v[48:51], v[8:11]
    v_perm_b32 v48, v201, v185, s39
    v_perm_b32 v49, v205, v189, s39
    v_perm_b32 v50, v209, v193, s39
    v_perm_b32 v51, v213, v197, s39
    v_mfma_f32_16x16x32_bf16 v[12:15], v[44:47], v[52:55], v[12:15]
    v_perm_b32 v52, v201, v185, s40
    v_perm_b32 v53, v205, v189, s40
    v_perm_b32 v54, v209, v193, s40
    v_perm_b32 v55, v213, v197, s40
    v_mfma_f32_16x16x32_bf16 v[16:19], v[44:47], v[48:51], v[16:19]
    s_nop 0
    v_mfma_f32_16x16x32_bf16 v[20:23], v[44:47], v[52:55], v[20:23]
    s_waitcnt vmcnt(4)
    buffer_load_dwordx4 v[148:151], v2, s[20:23], s37 offen offset:3072 nt
    v_perm_b32 v48, v202, v186, s39
    v_perm_b32 v49, v206, v190, s39
    v_perm_b32 v50, v210, v194, s39
    v_perm_b32 v51, v214, v198, s39
    v_perm_b32 v52, v202, v186, s40
    v_perm_b32 v53, v206, v190, s40
    v_perm_b32 v54, v210, v194, s40
    v_perm_b32 v55, v214, v198, s40
    v_mfma_f32_16x16x32_bf16 v[24:27], v[44:47], v[48:51], v[24:27]
    v_perm_b32 v48, v203, v187, s39
    v_perm_b32 v49, v207, v191, s39
    v_perm_b32 v50, v211, v195, s39
    v_perm_b32 v51, v215, v199, s39
    v_mfma_f32_16x16x32_bf16 v[28:31], v[44:47], v[52:55], v[28:31]
    v_perm_b32 v52, v203, v187, s40
    v_perm_b32 v53, v207, v191, s40
    v_perm_b32 v54, v211, v195, s40
    v_perm_b32 v55, v215, v199, s40
    v_mfma_f32_16x16x32_bf16 v[32:35], v[44:47], v[48:51], v[32:35]
    s_nop 0
    v_mfma_f32_16x16x32_bf16 v[36:39], v[44:47], v[52:55], v[36:39]
    s_waitcnt vmcnt(4)
    s_xor_b32 s37, s55, 0x50000
    buffer_load_dwordx4 v[152:155], v2, s[20:23], s37 offen offset:0 nt
    v_fma_f32 v61, v92, s38, -v60
    v_fma_f32 v62, v93, s38, -v60
    v_exp_f32 v61, v61
    v_exp_f32 v62, v62
    s_nop 0
    v_cvt_pk_bf16_f32 v44, v61, v62
    s_nop 1
    v_mov_b32_dpp v45, v44 row_ror:12 row_mask:0xf bank_mask:0xf
    v_mov_b32_dpp v46, v44 row_ror:8 row_mask:0xf bank_mask:0xf
    v_mov_b32_dpp v47, v44 row_ror:4 row_mask:0xf bank_mask:0xf
    s_nop 1
    v_mfma_f32_16x16x32_bf16 v[40:43], v[44:47], v[4:7], v[40:43]
    s_waitcnt vmcnt(4)
    buffer_load_dwordx4 v[156:159], v2, s[20:23], s37 offen offset:1024 nt
    s_waitcnt vmcnt(4)
    buffer_load_dwordx4 v[160:163], v2, s[20:23], s37 offen offset:2048 nt
    s_waitcnt vmcnt(4)
    buffer_load_dwordx4 v[164:167], v2, s[20:23], s37 offen offset:3072 nt
    s_waitcnt vmcnt(4)
    s_xor_b32 s37, s55, 0x5a000
    buffer_load_dwordx4 v[168:171], v2, s[20:23], s37 offen offset:0 nt
    v_perm_b32 v48, v136, v120, s39
    v_perm_b32 v49, v140, v124, s39
    v_perm_b32 v50, v144, v128, s39
    v_perm_b32 v51, v148, v132, s39
    v_perm_b32 v52, v136, v120, s40
    v_perm_b32 v53, v140, v124, s40
    v_perm_b32 v54, v144, v128, s40
    v_perm_b32 v55, v148, v132, s40
    v_mfma_f32_16x16x32_bf16 v[8:11], v[44:47], v[48:51], v[8:11]
    v_perm_b32 v48, v137, v121, s39
    v_perm_b32 v49, v141, v125, s39
    v_perm_b32 v50, v145, v129, s39
    v_perm_b32 v51, v149, v133, s39
    v_mfma_f32_16x16x32_bf16 v[12:15], v[44:47], v[52:55], v[12:15]
    v_perm_b32 v52, v137, v121, s40
    v_perm_b32 v53, v141, v125, s40
    v_perm_b32 v54, v145, v129, s40
    v_perm_b32 v55, v149, v133, s40
    v_mfma_f32_16x16x32_bf16 v[16:19], v[44:47], v[48:51], v[16:19]
    s_nop 0
    v_mfma_f32_16x16x32_bf16 v[20:23], v[44:47], v[52:55], v[20:23]
    s_waitcnt vmcnt(4)
    buffer_load_dwordx4 v[172:175], v2, s[20:23], s37 offen offset:1024 nt
    v_perm_b32 v48, v138, v122, s39
    v_perm_b32 v49, v142, v126, s39
    v_perm_b32 v50, v146, v130, s39
    v_perm_b32 v51, v150, v134, s39
    v_perm_b32 v52, v138, v122, s40
    v_perm_b32 v53, v142, v126, s40
    v_perm_b32 v54, v146, v130, s40
    v_perm_b32 v55, v150, v134, s40
    v_mfma_f32_16x16x32_bf16 v[24:27], v[44:47], v[48:51], v[24:27]
    v_perm_b32 v48, v139, v123, s39
    v_perm_b32 v49, v143, v127, s39
    v_perm_b32 v50, v147, v131, s39
    v_perm_b32 v51, v151, v135, s39
    v_mfma_f32_16x16x32_bf16 v[28:31], v[44:47], v[52:55], v[28:31]
    v_perm_b32 v52, v139, v123, s40
    v_perm_b32 v53, v143, v127, s40
    v_perm_b32 v54, v147, v131, s40
    v_perm_b32 v55, v151, v135, s40
    v_mfma_f32_16x16x32_bf16 v[32:35], v[44:47], v[48:51], v[32:35]
    s_nop 0
    v_mfma_f32_16x16x32_bf16 v[36:39], v[44:47], v[52:55], v[36:39]
    s_waitcnt vmcnt(4)
    buffer_load_dwordx4 v[176:179], v2, s[20:23], s37 offen offset:2048 nt
    v_fma_f32 v61, v94, s38, -v60
    v_fma_f32 v62, v95, s38, -v60
    v_exp_f32 v61, v61
    v_exp_f32 v62, v62
    s_nop 0
    v_cvt_pk_bf16_f32 v44, v61, v62
    s_nop 1
    v_mov_b32_dpp v45, v44 row_ror:12 row_mask:0xf bank_mask:0xf
    v_mov_b32_dpp v46, v44 row_ror:8 row_mask:0xf bank_mask:0xf
    v_mov_b32_dpp v47, v44 row_ror:4 row_mask:0xf bank_mask:0xf
    s_nop 1
    v_mfma_f32_16x16x32_bf16 v[40:43], v[44:47], v[4:7], v[40:43]
    s_waitcnt vmcnt(4)
    buffer_load_dwordx4 v[180:183], v2, s[20:23], s37 offen offset:3072 nt
    s_waitcnt vmcnt(4)
    s_xor_b32 s37, s55, 0xc000
    buffer_load_dwordx4 v[184:187], v2, s[20:23], s37 offen offset:0 nt
    s_waitcnt vmcnt(4)
    buffer_load_dwordx4 v[188:191], v2, s[20:23], s37 offen offset:1024 nt
    s_waitcnt vmcnt(4)
    buffer_load_dwordx4 v[192:195], v2, s[20:23], s37 offen offset:2048 nt
    s_waitcnt vmcnt(4)
    buffer_load_dwordx4 v[196:199], v2, s[20:23], s37 offen offset:3072 nt
    s_waitcnt vmcnt(4)
    s_xor_b32 s37, s55, 0x6000
    buffer_load_dwordx4 v[200:203], v2, s[20:23], s37 offen offset:0 nt
    v_perm_b32 v48, v168, v152, s39
    v_perm_b32 v49, v172, v156, s39
    v_perm_b32 v50, v176, v160, s39
    v_perm_b32 v51, v180, v164, s39
    v_perm_b32 v52, v168, v152, s40
    v_perm_b32 v53, v172, v156, s40
    v_perm_b32 v54, v176, v160, s40
    v_perm_b32 v55, v180, v164, s40
    v_mfma_f32_16x16x32_bf16 v[8:11], v[44:47], v[48:51], v[8:11]
    v_perm_b32 v48, v169, v153, s39
    v_perm_b32 v49, v173, v157, s39
    v_perm_b32 v50, v177, v161, s39
    v_perm_b32 v51, v181, v165, s39
    v_mfma_f32_16x16x32_bf16 v[12:15], v[44:47], v[52:55], v[12:15]
    v_perm_b32 v52, v169, v153, s40
    v_perm_b32 v53, v173, v157, s40
    v_perm_b32 v54, v177, v161, s40
    v_perm_b32 v55, v181, v165, s40
    v_mfma_f32_16x16x32_bf16 v[16:19], v[44:47], v[48:51], v[16:19]
    s_nop 0
    v_mfma_f32_16x16x32_bf16 v[20:23], v[44:47], v[52:55], v[20:23]
    s_waitcnt vmcnt(4)
    buffer_load_dwordx4 v[204:207], v2, s[20:23], s37 offen offset:1024 nt
    v_perm_b32 v48, v170, v154, s39
    v_perm_b32 v49, v174, v158, s39
    v_perm_b32 v50, v178, v162, s39
    v_perm_b32 v51, v182, v166, s39
    v_perm_b32 v52, v170, v154, s40
    v_perm_b32 v53, v174, v158, s40
    v_perm_b32 v54, v178, v162, s40
    v_perm_b32 v55, v182, v166, s40
    v_mfma_f32_16x16x32_bf16 v[24:27], v[44:47], v[48:51], v[24:27]
    v_perm_b32 v48, v171, v155, s39
    v_perm_b32 v49, v175, v159, s39
    v_perm_b32 v50, v179, v163, s39
    v_perm_b32 v51, v183, v167, s39
    v_mfma_f32_16x16x32_bf16 v[28:31], v[44:47], v[52:55], v[28:31]
    v_perm_b32 v52, v171, v155, s40
    v_perm_b32 v53, v175, v159, s40
    v_perm_b32 v54, v179, v163, s40
    v_perm_b32 v55, v183, v167, s40
    v_mfma_f32_16x16x32_bf16 v[32:35], v[44:47], v[48:51], v[32:35]
    s_nop 0
    v_mfma_f32_16x16x32_bf16 v[36:39], v[44:47], v[52:55], v[36:39]
    s_waitcnt vmcnt(4)
    buffer_load_dwordx4 v[208:211], v2, s[20:23], s37 offen offset:2048 nt
    v_fma_f32 v61, v96, s38, -v60
    v_fma_f32 v62, v97, s38, -v60
    v_exp_f32 v61, v61
    v_exp_f32 v62, v62
    s_nop 0
    v_cvt_pk_bf16_f32 v44, v61, v62
    s_nop 1
    v_mov_b32_dpp v45, v44 row_ror:12 row_mask:0xf bank_mask:0xf
    v_mov_b32_dpp v46, v44 row_ror:8 row_mask:0xf bank_mask:0xf
    v_mov_b32_dpp v47, v44 row_ror:4 row_mask:0xf bank_mask:0xf
    s_nop 1
    v_mfma_f32_16x16x32_bf16 v[40:43], v[44:47], v[4:7], v[40:43]
    s_waitcnt vmcnt(4)
    buffer_load_dwordx4 v[212:215], v2, s[20:23], s37 offen offset:3072 nt
    s_waitcnt vmcnt(4)
    s_xor_b32 s37, s55, 0x1c000
    buffer_load_dwordx4 v[120:123], v2, s[20:23], s37 offen offset:0 nt
    s_waitcnt vmcnt(4)
    buffer_load_dwordx4 v[124:127], v2, s[20:23], s37 offen offset:1024 nt
    s_waitcnt vmcnt(4)
    buffer_load_dwordx4 v[128:131], v2, s[20:23], s37 offen offset:2048 nt
    s_waitcnt vmcnt(4)
    buffer_load_dwordx4 v[132:135], v2, s[20:23], s37 offen offset:3072 nt
    s_waitcnt vmcnt(4)
    s_xor_b32 s37, s55, 0x16000
    buffer_load_dwordx4 v[136:139], v2, s[20:23], s37 offen offset:0 nt
    v_perm_b32 v48, v200, v184, s39
    v_perm_b32 v49, v204, v188, s39
    v_perm_b32 v50, v208, v192, s39
    v_perm_b32 v51, v212, v196, s39
    v_perm_b32 v52, v200, v184, s40
    v_perm_b32 v53, v204, v188, s40
    v_perm_b32 v54, v208, v192, s40
    v_perm_b32 v55, v212, v196, s40
    v_mfma_f32_16x16x32_bf16 v[8:11], v[44:47], v[48:51], v[8:11]
    v_perm_b32 v48, v201, v185, s39
    v_perm_b32 v49, v205, v189, s39
    v_perm_b32 v50, v209, v193, s39
    v_perm_b32 v51, v213, v197, s39
    v_mfma_f32_16x16x32_bf16 v[12:15], v[44:47], v[52:55], v[12:15]
    v_perm_b32 v52, v201, v185, s40
    v_perm_b32 v53, v205, v189, s40
    v_perm_b32 v54, v209, v193, s40
    v_perm_b32 v55, v213, v197, s40
    v_mfma_f32_16x16x32_bf16 v[16:19], v[44:47], v[48:51], v[16:19]
    s_nop 0
    v_mfma_f32_16x16x32_bf16 v[20:23], v[44:47], v[52:55], v[20:23]
    s_waitcnt vmcnt(4)
    buffer_load_dwordx4 v[140:143], v2, s[20:23], s37 offen offset:1024 nt
    v_perm_b32 v48, v202, v186, s39
    v_perm_b32 v49, v206, v190, s39
    v_perm_b32 v50, v210, v194, s39
    v_perm_b32 v51, v214, v198, s39
    v_perm_b32 v52, v202, v186, s40
    v_perm_b32 v53, v206, v190, s40
    v_perm_b32 v54, v210, v194, s40
    v_perm_b32 v55, v214, v198, s40
    v_mfma_f32_16x16x32_bf16 v[24:27], v[44:47], v[48:51], v[24:27]
    v_perm_b32 v48, v203, v187, s39
    v_perm_b32 v49, v207, v191, s39
    v_perm_b32 v50, v211, v195, s39
    v_perm_b32 v51, v215, v199, s39
    v_mfma_f32_16x16x32_bf16 v[28:31], v[44:47], v[52:55], v[28:31]
    v_perm_b32 v52, v203, v187, s40
    v_perm_b32 v53, v207, v191, s40
    v_perm_b32 v54, v211, v195, s40
    v_perm_b32 v55, v215, v199, s40
    v_mfma_f32_16x16x32_bf16 v[32:35], v[44:47], v[48:51], v[32:35]
    s_nop 0
    v_mfma_f32_16x16x32_bf16 v[36:39], v[44:47], v[52:55], v[36:39]
    s_waitcnt vmcnt(4)
    buffer_load_dwordx4 v[144:147], v2, s[20:23], s37 offen offset:2048 nt
    v_fma_f32 v61, v98, s38, -v60
    v_fma_f32 v62, v99, s38, -v60
    v_exp_f32 v61, v61
    v_exp_f32 v62, v62
    s_nop 0
    v_cvt_pk_bf16_f32 v44, v61, v62
    s_nop 1
    v_mov_b32_dpp v45, v44 row_ror:12 row_mask:0xf bank_mask:0xf
    v_mov_b32_dpp v46, v44 row_ror:8 row_mask:0xf bank_mask:0xf
    v_mov_b32_dpp v47, v44 row_ror:4 row_mask:0xf bank_mask:0xf
    s_nop 1
    v_mfma_f32_16x16x32_bf16 v[40:43], v[44:47], v[4:7], v[40:43]
    s_waitcnt vmcnt(4)
    buffer_load_dwordx4 v[148:151], v2, s[20:23], s37 offen offset:3072 nt
    s_waitcnt vmcnt(4)
    s_xor_b32 s37, s55, 0x4c000
    buffer_load_dwordx4 v[152:155], v2, s[20:23], s37 offen offset:0 nt
    s_waitcnt vmcnt(4)
    buffer_load_dwordx4 v[156:159], v2, s[20:23], s37 offen offset:1024 nt
    s_waitcnt vmcnt(4)
    buffer_load_dwordx4 v[160:163], v2, s[20:23], s37 offen offset:2048 nt
    s_waitcnt vmcnt(4)
    buffer_load_dwordx4 v[164:167], v2, s[20:23], s37 offen offset:3072 nt
    s_xor_b32 s37, s55, 0x46000
    buffer_load_dwordx4 v[168:171], v2, s[20:23], s37 offen offset:0 nt
    buffer_load_dwordx4 v[172:175], v2, s[20:23], s37 offen offset:1024 nt
    buffer_load_dwordx4 v[176:179], v2, s[20:23], s37 offen offset:2048 nt
    s_waitcnt vmcnt(7)
    buffer_load_dwordx4 v[180:183], v2, s[20:23], s37 offen offset:3072 nt
    v_perm_b32 v48, v136, v120, s39
    v_perm_b32 v49, v140, v124, s39
    v_perm_b32 v50, v144, v128, s39
    v_perm_b32 v51, v148, v132, s39
    v_perm_b32 v52, v136, v120, s40
    v_perm_b32 v53, v140, v124, s40
    v_perm_b32 v54, v144, v128, s40
    v_perm_b32 v55, v148, v132, s40
    v_mfma_f32_16x16x32_bf16 v[8:11], v[44:47], v[48:51], v[8:11]
    v_perm_b32 v48, v137, v121, s39
    v_perm_b32 v49, v141, v125, s39
    v_perm_b32 v50, v145, v129, s39
    v_perm_b32 v51, v149, v133, s39
    v_mfma_f32_16x16x32_bf16 v[12:15], v[44:47], v[52:55], v[12:15]
    v_perm_b32 v52, v137, v121, s40
    v_perm_b32 v53, v141, v125, s40
    v_perm_b32 v54, v145, v129, s40
    v_perm_b32 v55, v149, v133, s40
    v_mfma_f32_16x16x32_bf16 v[16:19], v[44:47], v[48:51], v[16:19]
    s_nop 0
    v_mfma_f32_16x16x32_bf16 v[20:23], v[44:47], v[52:55], v[20:23]
    s_waitcnt vmcnt(7)
    s_xor_b32 s37, s55, 0x5c000
    buffer_load_dwordx4 v[184:187], v2, s[20:23], s37 offen offset:0 nt
    v_perm_b32 v48, v138, v122, s39
    v_perm_b32 v49, v142, v126, s39
    v_perm_b32 v50, v146, v130, s39
    v_perm_b32 v51, v150, v134, s39
    v_perm_b32 v52, v138, v122, s40
    v_perm_b32 v53, v142, v126, s40
    v_perm_b32 v54, v146, v130, s40
    v_perm_b32 v55, v150, v134, s40
    v_mfma_f32_16x16x32_bf16 v[24:27], v[44:47], v[48:51], v[24:27]
    v_perm_b32 v48, v139, v123, s39
    v_perm_b32 v49, v143, v127, s39
    v_perm_b32 v50, v147, v131, s39
    v_perm_b32 v51, v151, v135, s39
    v_mfma_f32_16x16x32_bf16 v[28:31], v[44:47], v[52:55], v[28:31]
    v_perm_b32 v52, v139, v123, s40
    v_perm_b32 v53, v143, v127, s40
    v_perm_b32 v54, v147, v131, s40
    v_perm_b32 v55, v151, v135, s40
    v_mfma_f32_16x16x32_bf16 v[32:35], v[44:47], v[48:51], v[32:35]
    s_nop 0
    v_mfma_f32_16x16x32_bf16 v[36:39], v[44:47], v[52:55], v[36:39]
    s_waitcnt vmcnt(7)
    buffer_load_dwordx4 v[188:191], v2, s[20:23], s37 offen offset:1024 nt
    v_fma_f32 v61, v100, s38, -v60
    v_fma_f32 v62, v101, s38, -v60
    v_exp_f32 v61, v61
    v_exp_f32 v62, v62
    s_nop 0
    v_cvt_pk_bf16_f32 v44, v61, v62
    s_nop 1
    v_mov_b32_dpp v45, v44 row_ror:12 row_mask:0xf bank_mask:0xf
    v_mov_b32_dpp v46, v44 row_ror:8 row_mask:0xf bank_mask:0xf
    v_mov_b32_dpp v47, v44 row_ror:4 row_mask:0xf bank_mask:0xf
    s_nop 1
    v_mfma_f32_16x16x32_bf16 v[40:43], v[44:47], v[4:7], v[40:43]
    s_waitcnt vmcnt(7)
    buffer_load_dwordx4 v[192:195], v2, s[20:23], s37 offen offset:2048 nt
    s_waitcnt vmcnt(7)
    buffer_load_dwordx4 v[196:199], v2, s[20:23], s37 offen offset:3072 nt
    s_waitcnt vmcnt(7)
    s_xor_b32 s37, s55, 0x56000
    buffer_load_dwordx4 v[200:203], v2, s[20:23], s37 offen offset:0 nt
    s_waitcnt vmcnt(7)
    buffer_load_dwordx4 v[204:207], v2, s[20:23], s37 offen offset:1024 nt
    s_waitcnt vmcnt(7)
    buffer_load_dwordx4 v[208:211], v2, s[20:23], s37 offen offset:2048 nt
    s_waitcnt vmcnt(7)
    buffer_load_dwordx4 v[212:215], v2, s[20:23], s37 offen offset:3072 nt
    v_perm_b32 v48, v168, v152, s39
    v_perm_b32 v49, v172, v156, s39
    v_perm_b32 v50, v176, v160, s39
    v_perm_b32 v51, v180, v164, s39
    v_perm_b32 v52, v168, v152, s40
    v_perm_b32 v53, v172, v156, s40
    v_perm_b32 v54, v176, v160, s40
    v_perm_b32 v55, v180, v164, s40
    v_mfma_f32_16x16x32_bf16 v[8:11], v[44:47], v[48:51], v[8:11]
    v_perm_b32 v48, v169, v153, s39
    v_perm_b32 v49, v173, v157, s39
    v_perm_b32 v50, v177, v161, s39
    v_perm_b32 v51, v181, v165, s39
    v_mfma_f32_16x16x32_bf16 v[12:15], v[44:47], v[52:55], v[12:15]
    v_perm_b32 v52, v169, v153, s40
    v_perm_b32 v53, v173, v157, s40
    v_perm_b32 v54, v177, v161, s40
    v_perm_b32 v55, v181, v165, s40
    v_mfma_f32_16x16x32_bf16 v[16:19], v[44:47], v[48:51], v[16:19]
    s_nop 0
    v_mfma_f32_16x16x32_bf16 v[20:23], v[44:47], v[52:55], v[20:23]
    s_waitcnt vmcnt(7)
    s_xor_b32 s37, s55, 0x20000
    buffer_load_dwordx4 v[120:123], v2, s[20:23], s37 offen offset:0 nt
    v_perm_b32 v48, v170, v154, s39
    v_perm_b32 v49, v174, v158, s39
    v_perm_b32 v50, v178, v162, s39
    v_perm_b32 v51, v182, v166, s39
    v_perm_b32 v52, v170, v154, s40
    v_perm_b32 v53, v174, v158, s40
    v_perm_b32 v54, v178, v162, s40
    v_perm_b32 v55, v182, v166, s40
    v_mfma_f32_16x16x32_bf16 v[24:27], v[44:47], v[48:51], v[24:27]
    v_perm_b32 v48, v171, v155, s39
    v_perm_b32 v49, v175, v159, s39
    v_perm_b32 v50, v179, v163, s39
    v_perm_b32 v51, v183, v167, s39
    v_mfma_f32_16x16x32_bf16 v[28:31], v[44:47], v[52:55], v[28:31]
    v_perm_b32 v52, v171, v155, s40
    v_perm_b32 v53, v175, v159, s40
    v_perm_b32 v54, v179, v163, s40
    v_perm_b32 v55, v183, v167, s40
    v_mfma_f32_16x16x32_bf16 v[32:35], v[44:47], v[48:51], v[32:35]
    s_nop 0
    v_mfma_f32_16x16x32_bf16 v[36:39], v[44:47], v[52:55], v[36:39]
    s_waitcnt vmcnt(7)
    buffer_load_dwordx4 v[124:127], v2, s[20:23], s37 offen offset:1024 nt
    v_fma_f32 v61, v102, s38, -v60
    v_fma_f32 v62, v103, s38, -v60
    v_exp_f32 v61, v61
    v_exp_f32 v62, v62
    s_nop 0
    v_cvt_pk_bf16_f32 v44, v61, v62
    s_nop 1
    v_mov_b32_dpp v45, v44 row_ror:12 row_mask:0xf bank_mask:0xf
    v_mov_b32_dpp v46, v44 row_ror:8 row_mask:0xf bank_mask:0xf
    v_mov_b32_dpp v47, v44 row_ror:4 row_mask:0xf bank_mask:0xf
    s_nop 1
    v_mfma_f32_16x16x32_bf16 v[40:43], v[44:47], v[4:7], v[40:43]
    s_waitcnt vmcnt(7)
    buffer_load_dwordx4 v[128:131], v2, s[20:23], s37 offen offset:2048 nt
    s_waitcnt vmcnt(7)
    buffer_load_dwordx4 v[132:135], v2, s[20:23], s37 offen offset:3072 nt
    s_waitcnt vmcnt(7)
    s_xor_b32 s37, s55, 0x2a000
    buffer_load_dwordx4 v[136:139], v2, s[20:23], s37 offen offset:0 nt
    s_waitcnt vmcnt(7)
    buffer_load_dwordx4 v[140:143], v2, s[20:23], s37 offen offset:1024 nt
    s_waitcnt vmcnt(7)
    buffer_load_dwordx4 v[144:147], v2, s[20:23], s37 offen offset:2048 nt
    s_waitcnt vmcnt(7)
    buffer_load_dwordx4 v[148:151], v2, s[20:23], s37 offen offset:3072 nt
    v_perm_b32 v48, v200, v184, s39
    v_perm_b32 v49, v204, v188, s39
    v_perm_b32 v50, v208, v192, s39
    v_perm_b32 v51, v212, v196, s39
    v_perm_b32 v52, v200, v184, s40
    v_perm_b32 v53, v204, v188, s40
    v_perm_b32 v54, v208, v192, s40
    v_perm_b32 v55, v212, v196, s40
    v_mfma_f32_16x16x32_bf16 v[8:11], v[44:47], v[48:51], v[8:11]
    v_perm_b32 v48, v201, v185, s39
    v_perm_b32 v49, v205, v189, s39
    v_perm_b32 v50, v209, v193, s39
    v_perm_b32 v51, v213, v197, s39
    v_mfma_f32_16x16x32_bf16 v[12:15], v[44:47], v[52:55], v[12:15]
    v_perm_b32 v52, v201, v185, s40
    v_perm_b32 v53, v205, v189, s40
    v_perm_b32 v54, v209, v193, s40
    v_perm_b32 v55, v213, v197, s40
    v_mfma_f32_16x16x32_bf16 v[16:19], v[44:47], v[48:51], v[16:19]
    s_nop 0
    v_mfma_f32_16x16x32_bf16 v[20:23], v[44:47], v[52:55], v[20:23]
    s_waitcnt vmcnt(7)
    s_xor_b32 s37, s55, 0x30000
    buffer_load_dwordx4 v[152:155], v2, s[20:23], s37 offen offset:0 nt
    v_perm_b32 v48, v202, v186, s39
    v_perm_b32 v49, v206, v190, s39
    v_perm_b32 v50, v210, v194, s39
    v_perm_b32 v51, v214, v198, s39
    v_perm_b32 v52, v202, v186, s40
    v_perm_b32 v53, v206, v190, s40
    v_perm_b32 v54, v210, v194, s40
    v_perm_b32 v55, v214, v198, s40
    v_mfma_f32_16x16x32_bf16 v[24:27], v[44:47], v[48:51], v[24:27]
    v_perm_b32 v48, v203, v187, s39
    v_perm_b32 v49, v207, v191, s39
    v_perm_b32 v50, v211, v195, s39
    v_perm_b32 v51, v215, v199, s39
    v_mfma_f32_16x16x32_bf16 v[28:31], v[44:47], v[52:55], v[28:31]
    v_perm_b32 v52, v203, v187, s40
    v_perm_b32 v53, v207, v191, s40
    v_perm_b32 v54, v211, v195, s40
    v_perm_b32 v55, v215, v199, s40
    v_mfma_f32_16x16x32_bf16 v[32:35], v[44:47], v[48:51], v[32:35]
    s_nop 0
    v_mfma_f32_16x16x32_bf16 v[36:39], v[44:47], v[52:55], v[36:39]
    s_waitcnt vmcnt(7)
    buffer_load_dwordx4 v[156:159], v2, s[20:23], s37 offen offset:1024 nt
    v_fma_f32 v61, v104, s38, -v60
    v_fma_f32 v62, v105, s38, -v60
    v_exp_f32 v61, v61
    v_exp_f32 v62, v62
    s_nop 0
    v_cvt_pk_bf16_f32 v44, v61, v62
    s_nop 1
    v_mov_b32_dpp v45, v44 row_ror:12 row_mask:0xf bank_mask:0xf
    v_mov_b32_dpp v46, v44 row_ror:8 row_mask:0xf bank_mask:0xf
    v_mov_b32_dpp v47, v44 row_ror:4 row_mask:0xf bank_mask:0xf
    s_nop 1
    v_mfma_f32_16x16x32_bf16 v[40:43], v[44:47], v[4:7], v[40:43]
    s_waitcnt vmcnt(7)
    buffer_load_dwordx4 v[160:163], v2, s[20:23], s37 offen offset:2048 nt
    s_waitcnt vmcnt(7)
    buffer_load_dwordx4 v[164:167], v2, s[20:23], s37 offen offset:3072 nt
    s_waitcnt vmcnt(7)
    s_xor_b32 s37, s55, 0x3a000
    buffer_load_dwordx4 v[168:171], v2, s[20:23], s37 offen offset:0 nt
    s_waitcnt vmcnt(7)
    buffer_load_dwordx4 v[172:175], v2, s[20:23], s37 offen offset:1024 nt
    s_waitcnt vmcnt(7)
    buffer_load_dwordx4 v[176:179], v2, s[20:23], s37 offen offset:2048 nt
    s_waitcnt vmcnt(7)
    buffer_load_dwordx4 v[180:183], v2, s[20:23], s37 offen offset:3072 nt
    v_perm_b32 v48, v136, v120, s39
    v_perm_b32 v49, v140, v124, s39
    v_perm_b32 v50, v144, v128, s39
    v_perm_b32 v51, v148, v132, s39
    v_perm_b32 v52, v136, v120, s40
    v_perm_b32 v53, v140, v124, s40
    v_perm_b32 v54, v144, v128, s40
    v_perm_b32 v55, v148, v132, s40
    v_mfma_f32_16x16x32_bf16 v[8:11], v[44:47], v[48:51], v[8:11]
    v_perm_b32 v48, v137, v121, s39
    v_perm_b32 v49, v141, v125, s39
    v_perm_b32 v50, v145, v129, s39
    v_perm_b32 v51, v149, v133, s39
    v_mfma_f32_16x16x32_bf16 v[12:15], v[44:47], v[52:55], v[12:15]
    v_perm_b32 v52, v137, v121, s40
    v_perm_b32 v53, v141, v125, s40
    v_perm_b32 v54, v145, v129, s40
    v_perm_b32 v55, v149, v133, s40
    v_mfma_f32_16x16x32_bf16 v[16:19], v[44:47], v[48:51], v[16:19]
    s_nop 0
    v_mfma_f32_16x16x32_bf16 v[20:23], v[44:47], v[52:55], v[20:23]
    s_waitcnt vmcnt(7)
    s_xor_b32 s37, s55, 0x60000
    buffer_load_dwordx4 v[184:187], v2, s[20:23], s37 offen offset:0 nt
    v_perm_b32 v48, v138, v122, s39
    v_perm_b32 v49, v142, v126, s39
    v_perm_b32 v50, v146, v130, s39
    v_perm_b32 v51, v150, v134, s39
    v_perm_b32 v52, v138, v122, s40
    v_perm_b32 v53, v142, v126, s40
    v_perm_b32 v54, v146, v130, s40
    v_perm_b32 v55, v150, v134, s40
    v_mfma_f32_16x16x32_bf16 v[24:27], v[44:47], v[48:51], v[24:27]
    v_perm_b32 v48, v139, v123, s39
    v_perm_b32 v49, v143, v127, s39
    v_perm_b32 v50, v147, v131, s39
    v_perm_b32 v51, v151, v135, s39
    v_mfma_f32_16x16x32_bf16 v[28:31], v[44:47], v[52:55], v[28:31]
    v_perm_b32 v52, v139, v123, s40
    v_perm_b32 v53, v143, v127, s40
    v_perm_b32 v54, v147, v131, s40
    v_perm_b32 v55, v151, v135, s40
    v_mfma_f32_16x16x32_bf16 v[32:35], v[44:47], v[48:51], v[32:35]
    s_nop 0
    v_mfma_f32_16x16x32_bf16 v[36:39], v[44:47], v[52:55], v[36:39]
    s_waitcnt vmcnt(7)
    buffer_load_dwordx4 v[188:191], v2, s[20:23], s37 offen offset:1024 nt
    v_fma_f32 v61, v106, s38, -v60
    v_fma_f32 v62, v107, s38, -v60
    v_exp_f32 v61, v61
    v_exp_f32 v62, v62
    s_nop 0
    v_cvt_pk_bf16_f32 v44, v61, v62
    s_nop 1
    v_mov_b32_dpp v45, v44 row_ror:12 row_mask:0xf bank_mask:0xf
    v_mov_b32_dpp v46, v44 row_ror:8 row_mask:0xf bank_mask:0xf
    v_mov_b32_dpp v47, v44 row_ror:4 row_mask:0xf bank_mask:0xf
    s_nop 1
    v_mfma_f32_16x16x32_bf16 v[40:43], v[44:47], v[4:7], v[40:43]
    s_waitcnt vmcnt(7)
    buffer_load_dwordx4 v[192:195], v2, s[20:23], s37 offen offset:2048 nt
    s_waitcnt vmcnt(7)
    buffer_load_dwordx4 v[196:199], v2, s[20:23], s37 offen offset:3072 nt
    s_waitcnt vmcnt(7)
    s_xor_b32 s37, s55, 0x6a000
    buffer_load_dwordx4 v[200:203], v2, s[20:23], s37 offen offset:0 nt
    s_waitcnt vmcnt(7)
    buffer_load_dwordx4 v[204:207], v2, s[20:23], s37 offen offset:1024 nt
    s_waitcnt vmcnt(7)
    buffer_load_dwordx4 v[208:211], v2, s[20:23], s37 offen offset:2048 nt
    s_waitcnt vmcnt(7)
    buffer_load_dwordx4 v[212:215], v2, s[20:23], s37 offen offset:3072 nt
    v_perm_b32 v48, v168, v152, s39
    v_perm_b32 v49, v172, v156, s39
    v_perm_b32 v50, v176, v160, s39
    v_perm_b32 v51, v180, v164, s39
    v_perm_b32 v52, v168, v152, s40
    v_perm_b32 v53, v172, v156, s40
    v_perm_b32 v54, v176, v160, s40
    v_perm_b32 v55, v180, v164, s40
    v_mfma_f32_16x16x32_bf16 v[8:11], v[44:47], v[48:51], v[8:11]
    v_perm_b32 v48, v169, v153, s39
    v_perm_b32 v49, v173, v157, s39
    v_perm_b32 v50, v177, v161, s39
    v_perm_b32 v51, v181, v165, s39
    v_mfma_f32_16x16x32_bf16 v[12:15], v[44:47], v[52:55], v[12:15]
    v_perm_b32 v52, v169, v153, s40
    v_perm_b32 v53, v173, v157, s40
    v_perm_b32 v54, v177, v161, s40
    v_perm_b32 v55, v181, v165, s40
    v_mfma_f32_16x16x32_bf16 v[16:19], v[44:47], v[48:51], v[16:19]
    s_nop 0
    v_mfma_f32_16x16x32_bf16 v[20:23], v[44:47], v[52:55], v[20:23]
    s_waitcnt vmcnt(7)
    s_xor_b32 s37, s55, 0x70000
    buffer_load_dwordx4 v[120:123], v2, s[20:23], s37 offen offset:0 nt
    v_perm_b32 v48, v170, v154, s39
    v_perm_b32 v49, v174, v158, s39
    v_perm_b32 v50, v178, v162, s39
    v_perm_b32 v51, v182, v166, s39
    v_perm_b32 v52, v170, v154, s40
    v_perm_b32 v53, v174, v158, s40
    v_perm_b32 v54, v178, v162, s40
    v_perm_b32 v55, v182, v166, s40
    v_mfma_f32_16x16x32_bf16 v[24:27], v[44:47], v[48:51], v[24:27]
    v_perm_b32 v48, v171, v155, s39
    v_perm_b32 v49, v175, v159, s39
    v_perm_b32 v50, v179, v163, s39
    v_perm_b32 v51, v183, v167, s39
    v_mfma_f32_16x16x32_bf16 v[28:31], v[44:47], v[52:55], v[28:31]
    v_perm_b32 v52, v171, v155, s40
    v_perm_b32 v53, v175, v159, s40
    v_perm_b32 v54, v179, v163, s40
    v_perm_b32 v55, v183, v167, s40
    v_mfma_f32_16x16x32_bf16 v[32:35], v[44:47], v[48:51], v[32:35]
    s_nop 0
    v_mfma_f32_16x16x32_bf16 v[36:39], v[44:47], v[52:55], v[36:39]
    s_waitcnt vmcnt(7)
    buffer_load_dwordx4 v[124:127], v2, s[20:23], s37 offen offset:1024 nt
    v_fma_f32 v61, v108, s38, -v60
    v_fma_f32 v62, v109, s38, -v60
    v_exp_f32 v61, v61
    v_exp_f32 v62, v62
    s_nop 0
    v_cvt_pk_bf16_f32 v44, v61, v62
    s_nop 1
    v_mov_b32_dpp v45, v44 row_ror:12 row_mask:0xf bank_mask:0xf
    v_mov_b32_dpp v46, v44 row_ror:8 row_mask:0xf bank_mask:0xf
    v_mov_b32_dpp v47, v44 row_ror:4 row_mask:0xf bank_mask:0xf
    s_nop 1
    v_mfma_f32_16x16x32_bf16 v[40:43], v[44:47], v[4:7], v[40:43]
    s_waitcnt vmcnt(7)
    buffer_load_dwordx4 v[128:131], v2, s[20:23], s37 offen offset:2048 nt
    s_waitcnt vmcnt(7)
    buffer_load_dwordx4 v[132:135], v2, s[20:23], s37 offen offset:3072 nt
    s_waitcnt vmcnt(7)
    s_xor_b32 s37, s55, 0x7a000
    buffer_load_dwordx4 v[136:139], v2, s[20:23], s37 offen offset:0 nt
    s_waitcnt vmcnt(7)
    buffer_load_dwordx4 v[140:143], v2, s[20:23], s37 offen offset:1024 nt
    s_waitcnt vmcnt(7)
    buffer_load_dwordx4 v[144:147], v2, s[20:23], s37 offen offset:2048 nt
    s_waitcnt vmcnt(7)
    buffer_load_dwordx4 v[148:151], v2, s[20:23], s37 offen offset:3072 nt
    v_perm_b32 v48, v200, v184, s39
    v_perm_b32 v49, v204, v188, s39
    v_perm_b32 v50, v208, v192, s39
    v_perm_b32 v51, v212, v196, s39
    v_perm_b32 v52, v200, v184, s40
    v_perm_b32 v53, v204, v188, s40
    v_perm_b32 v54, v208, v192, s40
    v_perm_b32 v55, v212, v196, s40
    v_mfma_f32_16x16x32_bf16 v[8:11], v[44:47], v[48:51], v[8:11]
    v_perm_b32 v48, v201, v185, s39
    v_perm_b32 v49, v205, v189, s39
    v_perm_b32 v50, v209, v193, s39
    v_perm_b32 v51, v213, v197, s39
    v_mfma_f32_16x16x32_bf16 v[12:15], v[44:47], v[52:55], v[12:15]
    v_perm_b32 v52, v201, v185, s40
    v_perm_b32 v53, v205, v189, s40
    v_perm_b32 v54, v209, v193, s40
    v_perm_b32 v55, v213, v197, s40
    v_mfma_f32_16x16x32_bf16 v[16:19], v[44:47], v[48:51], v[16:19]
    s_nop 0
    v_mfma_f32_16x16x32_bf16 v[20:23], v[44:47], v[52:55], v[20:23]
    s_waitcnt vmcnt(7)
    s_xor_b32 s37, s55, 0x2c000
    buffer_load_dwordx4 v[152:155], v2, s[20:23], s37 offen offset:0 nt
    v_perm_b32 v48, v202, v186, s39
    v_perm_b32 v49, v206, v190, s39
    v_perm_b32 v50, v210, v194, s39
    v_perm_b32 v51, v214, v198, s39
    v_perm_b32 v52, v202, v186, s40
    v_perm_b32 v53, v206, v190, s40
    v_perm_b32 v54, v210, v194, s40
    v_perm_b32 v55, v214, v198, s40
    v_mfma_f32_16x16x32_bf16 v[24:27], v[44:47], v[48:51], v[24:27]
    v_perm_b32 v48, v203, v187, s39
    v_perm_b32 v49, v207, v191, s39
    v_perm_b32 v50, v211, v195, s39
    v_perm_b32 v51, v215, v199, s39
    v_mfma_f32_16x16x32_bf16 v[28:31], v[44:47], v[52:55], v[28:31]
    v_perm_b32 v52, v203, v187, s40
    v_perm_b32 v53, v207, v191, s40
    v_perm_b32 v54, v211, v195, s40
    v_perm_b32 v55, v215, v199, s40
    v_mfma_f32_16x16x32_bf16 v[32:35], v[44:47], v[48:51], v[32:35]
    s_nop 0
    v_mfma_f32_16x16x32_bf16 v[36:39], v[44:47], v[52:55], v[36:39]
    s_waitcnt vmcnt(7)
    buffer_load_dwordx4 v[156:159], v2, s[20:23], s37 offen offset:1024 nt
    v_fma_f32 v61, v110, s38, -v60
    v_fma_f32 v62, v111, s38, -v60
    v_exp_f32 v61, v61
    v_exp_f32 v62, v62
    s_nop 0
    v_cvt_pk_bf16_f32 v44, v61, v62
    s_nop 1
    v_mov_b32_dpp v45, v44 row_ror:12 row_mask:0xf bank_mask:0xf
    v_mov_b32_dpp v46, v44 row_ror:8 row_mask:0xf bank_mask:0xf
    v_mov_b32_dpp v47, v44 row_ror:4 row_mask:0xf bank_mask:0xf
    s_nop 1
    v_mfma_f32_16x16x32_bf16 v[40:43], v[44:47], v[4:7], v[40:43]
    s_waitcnt vmcnt(7)
    buffer_load_dwordx4 v[160:163], v2, s[20:23], s37 offen offset:2048 nt
    s_waitcnt vmcnt(7)
    buffer_load_dwordx4 v[164:167], v2, s[20:23], s37 offen offset:3072 nt
    s_waitcnt vmcnt(7)
    s_xor_b32 s37, s55, 0x26000
    buffer_load_dwordx4 v[168:171], v2, s[20:23], s37 offen offset:0 nt
    s_waitcnt vmcnt(7)
    buffer_load_dwordx4 v[172:175], v2, s[20:23], s37 offen offset:1024 nt
    s_waitcnt vmcnt(7)
    buffer_load_dwordx4 v[176:179], v2, s[20:23], s37 offen offset:2048 nt
    s_waitcnt vmcnt(7)
    buffer_load_dwordx4 v[180:183], v2, s[20:23], s37 offen offset:3072 nt
    v_perm_b32 v48, v136, v120, s39
    v_perm_b32 v49, v140, v124, s39
    v_perm_b32 v50, v144, v128, s39
    v_perm_b32 v51, v148, v132, s39
    v_perm_b32 v52, v136, v120, s40
    v_perm_b32 v53, v140, v124, s40
    v_perm_b32 v54, v144, v128, s40
    v_perm_b32 v55, v148, v132, s40
    v_mfma_f32_16x16x32_bf16 v[8:11], v[44:47], v[48:51], v[8:11]
    v_perm_b32 v48, v137, v121, s39
    v_perm_b32 v49, v141, v125, s39
    v_perm_b32 v50, v145, v129, s39
    v_perm_b32 v51, v149, v133, s39
    v_mfma_f32_16x16x32_bf16 v[12:15], v[44:47], v[52:55], v[12:15]
    v_perm_b32 v52, v137, v121, s40
    v_perm_b32 v53, v141, v125, s40
    v_perm_b32 v54, v145, v129, s40
    v_perm_b32 v55, v149, v133, s40
    v_mfma_f32_16x16x32_bf16 v[16:19], v[44:47], v[48:51], v[16:19]
    s_nop 0
    v_mfma_f32_16x16x32_bf16 v[20:23], v[44:47], v[52:55], v[20:23]
    s_waitcnt vmcnt(7)
    s_xor_b32 s37, s55, 0x3c000
    buffer_load_dwordx4 v[184:187], v2, s[20:23], s37 offen offset:0 nt
    v_perm_b32 v48, v138, v122, s39
    v_perm_b32 v49, v142, v126, s39
    v_perm_b32 v50, v146, v130, s39
    v_perm_b32 v51, v150, v134, s39
    v_perm_b32 v52, v138, v122, s40
    v_perm_b32 v53, v142, v126, s40
    v_perm_b32 v54, v146, v130, s40
    v_perm_b32 v55, v150, v134, s40
    v_mfma_f32_16x16x32_bf16 v[24:27], v[44:47], v[48:51], v[24:27]
    v_perm_b32 v48, v139, v123, s39
    v_perm_b32 v49, v143, v127, s39
    v_perm_b32 v50, v147, v131, s39
    v_perm_b32 v51, v151, v135, s39
    v_mfma_f32_16x16x32_bf16 v[28:31], v[44:47], v[52:55], v[28:31]
    v_perm_b32 v52, v139, v123, s40
    v_perm_b32 v53, v143, v127, s40
    v_perm_b32 v54, v147, v131, s40
    v_perm_b32 v55, v151, v135, s40
    v_mfma_f32_16x16x32_bf16 v[32:35], v[44:47], v[48:51], v[32:35]
    s_nop 0
    v_mfma_f32_16x16x32_bf16 v[36:39], v[44:47], v[52:55], v[36:39]
    s_waitcnt vmcnt(7)
    buffer_load_dwordx4 v[188:191], v2, s[20:23], s37 offen offset:1024 nt
    v_fma_f32 v61, v112, s38, -v60
    v_fma_f32 v62, v113, s38, -v60
    v_exp_f32 v61, v61
    v_exp_f32 v62, v62
    s_nop 0
    v_cvt_pk_bf16_f32 v44, v61, v62
    s_nop 1
    v_mov_b32_dpp v45, v44 row_ror:12 row_mask:0xf bank_mask:0xf
    v_mov_b32_dpp v46, v44 row_ror:8 row_mask:0xf bank_mask:0xf
    v_mov_b32_dpp v47, v44 row_ror:4 row_mask:0xf bank_mask:0xf
    s_nop 1
    v_mfma_f32_16x16x32_bf16 v[40:43], v[44:47], v[4:7], v[40:43]
    s_waitcnt vmcnt(7)
    buffer_load_dwordx4 v[192:195], v2, s[20:23], s37 offen offset:2048 nt
    s_waitcnt vmcnt(7)
    buffer_load_dwordx4 v[196:199], v2, s[20:23], s37 offen offset:3072 nt
    s_waitcnt vmcnt(7)
    s_xor_b32 s37, s55, 0x36000
    buffer_load_dwordx4 v[200:203], v2, s[20:23], s37 offen offset:0 nt
    s_waitcnt vmcnt(7)
    buffer_load_dwordx4 v[204:207], v2, s[20:23], s37 offen offset:1024 nt
    s_waitcnt vmcnt(7)
    buffer_load_dwordx4 v[208:211], v2, s[20:23], s37 offen offset:2048 nt
    s_waitcnt vmcnt(7)
    buffer_load_dwordx4 v[212:215], v2, s[20:23], s37 offen offset:3072 nt
    v_perm_b32 v48, v168, v152, s39
    v_perm_b32 v49, v172, v156, s39
    v_perm_b32 v50, v176, v160, s39
    v_perm_b32 v51, v180, v164, s39
    v_perm_b32 v52, v168, v152, s40
    v_perm_b32 v53, v172, v156, s40
    v_perm_b32 v54, v176, v160, s40
    v_perm_b32 v55, v180, v164, s40
    v_mfma_f32_16x16x32_bf16 v[8:11], v[44:47], v[48:51], v[8:11]
    v_perm_b32 v48, v169, v153, s39
    v_perm_b32 v49, v173, v157, s39
    v_perm_b32 v50, v177, v161, s39
    v_perm_b32 v51, v181, v165, s39
    v_mfma_f32_16x16x32_bf16 v[12:15], v[44:47], v[52:55], v[12:15]
    v_perm_b32 v52, v169, v153, s40
    v_perm_b32 v53, v173, v157, s40
    v_perm_b32 v54, v177, v161, s40
    v_perm_b32 v55, v181, v165, s40
    v_mfma_f32_16x16x32_bf16 v[16:19], v[44:47], v[48:51], v[16:19]
    s_nop 0
    v_mfma_f32_16x16x32_bf16 v[20:23], v[44:47], v[52:55], v[20:23]
    s_waitcnt vmcnt(7)
    s_xor_b32 s37, s55, 0x6c000
    buffer_load_dwordx4 v[120:123], v2, s[20:23], s37 offen offset:0 nt
    v_perm_b32 v48, v170, v154, s39
    v_perm_b32 v49, v174, v158, s39
    v_perm_b32 v50, v178, v162, s39
    v_perm_b32 v51, v182, v166, s39
    v_perm_b32 v52, v170, v154, s40
    v_perm_b32 v53, v174, v158, s40
    v_perm_b32 v54, v178, v162, s40
    v_perm_b32 v55, v182, v166, s40
    v_mfma_f32_16x16x32_bf16 v[24:27], v[44:47], v[48:51], v[24:27]
    v_perm_b32 v48, v171, v155, s39
    v_perm_b32 v49, v175, v159, s39
    v_perm_b32 v50, v179, v163, s39
    v_perm_b32 v51, v183, v167, s39
    v_mfma_f32_16x16x32_bf16 v[28:31], v[44:47], v[52:55], v[28:31]
    v_perm_b32 v52, v171, v155, s40
    v_perm_b32 v53, v175, v159, s40
    v_perm_b32 v54, v179, v163, s40
    v_perm_b32 v55, v183, v167, s40
    v_mfma_f32_16x16x32_bf16 v[32:35], v[44:47], v[48:51], v[32:35]
    s_nop 0
    v_mfma_f32_16x16x32_bf16 v[36:39], v[44:47], v[52:55], v[36:39]
    s_waitcnt vmcnt(7)
    buffer_load_dwordx4 v[124:127], v2, s[20:23], s37 offen offset:1024 nt
    v_fma_f32 v61, v114, s38, -v60
    v_fma_f32 v62, v115, s38, -v60
    v_exp_f32 v61, v61
    v_exp_f32 v62, v62
    s_nop 0
    v_cvt_pk_bf16_f32 v44, v61, v62
    s_nop 1
    v_mov_b32_dpp v45, v44 row_ror:12 row_mask:0xf bank_mask:0xf
    v_mov_b32_dpp v46, v44 row_ror:8 row_mask:0xf bank_mask:0xf
    v_mov_b32_dpp v47, v44 row_ror:4 row_mask:0xf bank_mask:0xf
    s_nop 1
    v_mfma_f32_16x16x32_bf16 v[40:43], v[44:47], v[4:7], v[40:43]
    s_waitcnt vmcnt(7)
    buffer_load_dwordx4 v[128:131], v2, s[20:23], s37 offen offset:2048 nt
    s_waitcnt vmcnt(7)
    buffer_load_dwordx4 v[132:135], v2, s[20:23], s37 offen offset:3072 nt
    s_waitcnt vmcnt(7)
    s_xor_b32 s37, s55, 0x66000
    buffer_load_dwordx4 v[136:139], v2, s[20:23], s37 offen offset:0 nt
    s_waitcnt vmcnt(7)
    buffer_load_dwordx4 v[140:143], v2, s[20:23], s37 offen offset:1024 nt
    s_cmp_lg_u32 s44, 0
    s_cbranch_scc1 L_notick
    s_mov_b32 s45, 1
    s_atomic_add s45, s[12:13], 0 glc
L_notick:
    s_waitcnt vmcnt(7)
    buffer_load_dwordx4 v[144:147], v2, s[20:23], s37 offen offset:2048 nt
    s_waitcnt vmcnt(7)
    buffer_load_dwordx4 v[148:151], v2, s[20:23], s37 offen offset:3072 nt
    v_perm_b32 v48, v200, v184, s39
    v_perm_b32 v49, v204, v188, s39
    v_perm_b32 v50, v208, v192, s39
    v_perm_b32 v51, v212, v196, s39
    v_perm_b32 v52, v200, v184, s40
    v_perm_b32 v53, v204, v188, s40
    v_perm_b32 v54, v208, v192, s40
    v_perm_b32 v55, v212, v196, s40
    v_mfma_f32_16x16x32_bf16 v[8:11], v[44:47], v[48:51], v[8:11]
    v_perm_b32 v48, v201, v185, s39
    v_perm_b32 v49, v205, v189, s39
    v_perm_b32 v50, v209, v193, s39
    v_perm_b32 v51, v213, v197, s39
    v_mfma_f32_16x16x32_bf16 v[12:15], v[44:47], v[52:55], v[12:15]
    v_perm_b32 v52, v201, v185, s40
    v_perm_b32 v53, v205, v189, s40
    v_perm_b32 v54, v209, v193, s40
    v_perm_b32 v55, v213, v197, s40
    v_mfma_f32_16x16x32_bf16 v[16:19], v[44:47], v[48:51], v[16:19]
    s_nop 0
    v_mfma_f32_16x16x32_bf16 v[20:23], v[44:47], v[52:55], v[20:23]
    s_waitcnt vmcnt(7)
    s_xor_b32 s37, s55, 0x7c000
    buffer_load_dwordx4 v[152:155], v2, s[20:23], s37 offen offset:0 nt
    v_perm_b32 v48, v202, v186, s39
    v_perm_b32 v49, v206, v190, s39
    v_perm_b32 v50, v210, v194, s39
    v_perm_b32 v51, v214, v198, s39
    v_perm_b32 v52, v202, v186, s40
    v_perm_b32 v53, v206, v190, s40
    v_perm_b32 v54, v210, v194, s40
    v_perm_b32 v55, v214, v198, s40
    v_mfma_f32_16x16x32_bf16 v[24:27], v[44:47], v[48:51], v[24:27]
    v_perm_b32 v48, v203, v187, s39
    v_perm_b32 v49, v207, v191, s39
    v_perm_b32 v50, v211, v195, s39
    v_perm_b32 v51, v215, v199, s39
    v_mfma_f32_16x16x32_bf16 v[28:31], v[44:47], v[52:55], v[28:31]
    v_perm_b32 v52, v203, v187, s40
    v_perm_b32 v53, v207, v191, s40
    v_perm_b32 v54, v211, v195, s40
    v_perm_b32 v55, v215, v199, s40
    v_mfma_f32_16x16x32_bf16 v[32:35], v[44:47], v[48:51], v[32:35]
    s_nop 0
    v_mfma_f32_16x16x32_bf16 v[36:39], v[44:47], v[52:55], v[36:39]
    s_waitcnt vmcnt(7)
    buffer_load_dwordx4 v[156:159], v2, s[20:23], s37 offen offset:1024 nt
    v_fma_f32 v61, v116, s38, -v60
    v_fma_f32 v62, v117, s38, -v60
    v_exp_f32 v61, v61
    v_exp_f32 v62, v62
    s_nop 0
    v_cvt_pk_bf16_f32 v44, v61, v62
    s_nop 1
    v_mov_b32_dpp v45, v44 row_ror:12 row_mask:0xf bank_mask:0xf
    v_mov_b32_dpp v46, v44 row_ror:8 row_mask:0xf bank_mask:0xf
    v_mov_b32_dpp v47, v44 row_ror:4 row_mask:0xf bank_mask:0xf
    s_nop 1
    v_mfma_f32_16x16x32_bf16 v[40:43], v[44:47], v[4:7], v[40:43]
    s_waitcnt vmcnt(7)
    buffer_load_dwordx4 v[160:163], v2, s[20:23], s37 offen offset:2048 nt
    s_waitcnt vmcnt(7)
    buffer_load_dwordx4 v[164:167], v2, s[20:23], s37 offen offset:3072 nt
    s_waitcnt vmcnt(7)
    s_xor_b32 s37, s55, 0x76000
    buffer_load_dwordx4 v[168:171], v2, s[20:23], s37 offen offset:0 nt
    s_waitcnt vmcnt(7)
    buffer_load_dwordx4 v[172:175], v2, s[20:23], s37 offen offset:1024 nt
    s_cmp_lg_u32 s44, 0
    s_cbranch_scc1 L_norole
    s_waitcnt lgkmcnt(0)
    s_add_u32 s45, s45, 1
    v_mov_b32 v59, s45
    ds_write_b32 v64, v59 offset:0
L_norole:
    s_waitcnt vmcnt(7)
    buffer_load_dwordx4 v[176:179], v2, s[20:23], s37 offen offset:2048 nt
    s_waitcnt vmcnt(7)
    buffer_load_dwordx4 v[180:183], v2, s[20:23], s37 offen offset:3072 nt
    v_perm_b32 v48, v136, v120, s39
    v_perm_b32 v49, v140, v124, s39
    v_perm_b32 v50, v144, v128, s39
    v_perm_b32 v51, v148, v132, s39
    v_perm_b32 v52, v136, v120, s40
    v_perm_b32 v53, v140, v124, s40
    v_perm_b32 v54, v144, v128, s40
    v_perm_b32 v55, v148, v132, s40
    v_mfma_f32_16x16x32_bf16 v[8:11], v[44:47], v[48:51], v[8:11]
    v_perm_b32 v48, v137, v121, s39
    v_perm_b32 v49, v141, v125, s39
    v_perm_b32 v50, v145, v129, s39
    v_perm_b32 v51, v149, v133, s39
    v_mfma_f32_16x16x32_bf16 v[12:15], v[44:47], v[52:55], v[12:15]
    v_perm_b32 v52, v137, v121, s40
    v_perm_b32 v53, v141, v125, s40
    v_perm_b32 v54, v145, v129, s40
    v_perm_b32 v55, v149, v133, s40
    v_mfma_f32_16x16x32_bf16 v[16:19], v[44:47], v[48:51], v[16:19]
    s_nop 0
    v_mfma_f32_16x16x32_bf16 v[20:23], v[44:47], v[52:55], v[20:23]
    v_perm_b32 v48, v138, v122, s39
    v_perm_b32 v49, v142, v126, s39
    v_perm_b32 v50, v146, v130, s39
    v_perm_b32 v51, v150, v134, s39
    v_perm_b32 v52, v138, v122, s40
    v_perm_b32 v53, v142, v126, s40
    v_perm_b32 v54, v146, v130, s40
    v_perm_b32 v55, v150, v134, s40
    v_mfma_f32_16x16x32_bf16 v[24:27], v[44:47], v[48:51], v[24:27]
    v_perm_b32 v48, v139, v123, s39
    v_perm_b32 v49, v143, v127, s39
    v_perm_b32 v50, v147, v131, s39
    v_perm_b32 v51, v151, v135, s39
    v_mfma_f32_16x16x32_bf16 v[28:31], v[44:47], v[52:55], v[28:31]
    v_perm_b32 v52, v139, v123, s40
    v_perm_b32 v53, v143, v127, s40
    v_perm_b32 v54, v147, v131, s40
    v_perm_b32 v55, v151, v135, s40
    v_mfma_f32_16x16x32_bf16 v[32:35], v[44:47], v[48:51], v[32:35]
    s_nop 0
    v_mfma_f32_16x16x32_bf16 v[36:39], v[44:47], v[52:55], v[36:39]
    v_fma_f32 v61, v118, s38, -v60
    v_fma_f32 v62, v119, s38, -v60
    v_exp_f32 v61, v61
    v_exp_f32 v62, v62
    s_nop 0
    v_cvt_pk_bf16_f32 v44, v61, v62
    s_nop 1
    v_mov_b32_dpp v45, v44 row_ror:12 row_mask:0xf bank_mask:0xf
    v_mov_b32_dpp v46, v44 row_ror:8 row_mask:0xf bank_mask:0xf
    v_mov_b32_dpp v47, v44 row_ror:4 row_mask:0xf bank_mask:0xf
    s_nop 1
    v_mfma_f32_16x16x32_bf16 v[40:43], v[44:47], v[4:7], v[40:43]
    s_waitcnt vmcnt(0)
    ds_read_b32 v59, v64 offset:0
    v_perm_b32 v48, v168, v152, s39
    v_perm_b32 v49, v172, v156, s39
    v_perm_b32 v50, v176, v160, s39
    v_perm_b32 v51, v180, v164, s39
    v_perm_b32 v52, v168, v152, s40
    v_perm_b32 v53, v172, v156, s40
    v_perm_b32 v54, v176, v160, s40
    v_perm_b32 v55, v180, v164, s40
    v_mfma_f32_16x16x32_bf16 v[8:11], v[44:47], v[48:51], v[8:11]
    v_perm_b32 v48, v169, v153, s39
    v_perm_b32 v49, v173, v157, s39
    v_perm_b32 v50, v177, v161, s39
    v_perm_b32 v51, v181, v165, s39
    v_mfma_f32_16x16x32_bf16 v[12:15], v[44:47], v[52:55], v[12:15]
    v_perm_b32 v52, v169, v153, s40
    v_perm_b32 v53, v173, v157, s40
    v_perm_b32 v54, v177, v161, s40
    v_perm_b32 v55, v181, v165, s40
    v_mfma_f32_16x16x32_bf16 v[16:19], v[44:47], v[48:51], v[16:19]
    s_nop 0
    v_mfma_f32_16x16x32_bf16 v[20:23], v[44:47], v[52:55], v[20:23]
    v_perm_b32 v48, v170, v154, s39
    v_perm_b32 v49, v174, v158, s39
    v_perm_b32 v50, v178, v162, s39
    v_perm_b32 v51, v182, v166, s39
    v_perm_b32 v52, v170, v154, s40
    v_perm_b32 v53, v174, v158, s40
    v_perm_b32 v54, v178, v162, s40
    v_perm_b32 v55, v182, v166, s40
    v_mfma_f32_16x16x32_bf16 v[24:27], v[44:47], v[48:51], v[24:27]
    v_perm_b32 v48, v171, v155, s39
    v_perm_b32 v49, v175, v159, s39
    v_perm_b32 v50, v179, v163, s39
    v_perm_b32 v51, v183, v167, s39
    v_mfma_f32_16x16x32_bf16 v[28:31], v[44:47], v[52:55], v[28:31]
    v_perm_b32 v52, v171, v155, s40
    v_perm_b32 v53, v175, v159, s40
    v_perm_b32 v54, v179, v163, s40
    v_perm_b32 v55, v183, v167, s40
    v_mfma_f32_16x16x32_bf16 v[32:35], v[44:47], v[48:51], v[32:35]
    s_nop 0
    v_mfma_f32_16x16x32_bf16 v[36:39], v[44:47], v[52:55], v[36:39]
    s_waitcnt lgkmcnt(0)
    v_readfirstlane_b32 s46, v59
    s_cmp_eq_u32 s46, 4
    s_cselect_b32 s50, s47, 0x7000000
    s_cselect_b32 s51, s48, 0x7000000
    s_cselect_b32 s52, s49, 0x7000000
    buffer_load_dwordx4 v[68:71], v2, s[28:31], s50 offen sc1
    buffer_load_dwordx4 v[72:75], v2, s[28:31], s51 offen sc1
    buffer_load_dwordx4 v[76:79], v2, s[28:31], s52 offen sc1
    s_mul_i32 s41, s44, 2064
    v_add_u32 v57, s41, v2
    v_readlane_b32 s42, v60, s44
    s_mov_b64 exec, 1
    ds_write_b128 v57, v[40:43] offset:2176
    s_mov_b64 exec, 0xffff
    ds_write_b128 v57, v[8:11] offset:128
    ds_write_b128 v57, v[12:15] offset:384
    ds_write_b128 v57, v[16:19] offset:640
    ds_write_b128 v57, v[20:23] offset:896
    s_nop 1
    ds_write_b128 v57, v[24:27] offset:1152
    ds_write_b128 v57, v[28:31] offset:1408
    ds_write_b128 v57, v[32:35] offset:1664
    ds_write_b128 v57, v[36:39] offset:1920
    s_mov_b64 exec, -1
    v_mov_b32 v46, s42
    v_lshlrev_b32 v58, 2, v3
    s_waitcnt lgkmcnt(0)
    s_barrier
    ds_read_b32 v96, v86 offset:128
    ds_read_b32 v97, v86 offset:384
    ds_read_b32 v98, v86 offset:2192
    ds_read_b32 v99, v86 offset:2448
    ds_read_b32 v100, v86 offset:4256
    ds_read_b32 v101, v86 offset:4512
    ds_read_b32 v102, v86 offset:6320
    ds_read_b32 v103, v86 offset:6576
    ds_read_b32 v88, v87 offset:2176
    ds_read_b32 v89, v87 offset:4240
    ds_read_b32 v90, v87 offset:6304
    ds_read_b32 v91, v87 offset:8368
    ds_read_b32 v59, v64 offset:0
    s_waitcnt lgkmcnt(5)
    v_add_f32 v44, v96, v98
    v_add_f32 v100, v100, v102
    v_add_f32 v45, v97, v99
    v_add_f32 v101, v101, v103
    v_add_f32 v44, v44, v100
    v_add_f32 v45, v45, v101
    s_waitcnt lgkmcnt(0)
    v_readfirstlane_b32 s46, v59
    v_add_f32 v47, v88, v89
    v_add_f32 v90, v90, v91
    v_add_f32 v47, v47, v90
    v_or_b32 v44, 1, v44
    v_or_b32 v45, 1, v45
    v_or_b32 v46, 1, v46
    v_or_b32 v47, 1, v47
    s_cmp_eq_u32 s46, 4
    s_cbranch_scc1 L_comb
    buffer_store_dwordx4 v[44:47], v2, s[28:31], s53 offen sc1
    s_endpgm
L_comb:
    s_mov_b32 s54, 0
L_chk:
    s_waitcnt vmcnt(0)
    v_and_b32 v16, v68, v69
    v_and_b32 v17, v72, v73
    v_and_b32 v18, v76, v77
    v_and_b32 v16, v16, v70
    v_and_b32 v17, v17, v74
    v_and_b32 v18, v18, v78
    v_and_b32 v16, v16, v71
    v_and_b32 v17, v17, v75
    v_and_b32 v18, v18, v79
    v_and_b32 v59, v16, v17
    v_and_b32 v59, v59, v18
    v_and_b32 v59, 1, v59
    v_cmp_ne_u32 vcc, 1, v59
    s_cbranch_vccz L_ok
    s_add_u32 s54, s54, 1
    s_cmp_gt_u32 s54, 0x100000
    s_cbranch_scc1 L_ok
    v_and_b32 v59, 1, v16
    v_cmp_ne_u32 vcc, 1, v59
    s_cbranch_vccz L_skip0
    buffer_load_dwordx4 v[68:71], v2, s[28:31], s47 offen sc1
L_skip0:
    v_and_b32 v59, 1, v17
    v_cmp_ne_u32 vcc, 1, v59
    s_cbranch_vccz L_skip1
    buffer_load_dwordx4 v[72:75], v2, s[28:31], s48 offen sc1
L_skip1:
    v_and_b32 v59, 1, v18
    v_cmp_ne_u32 vcc, 1, v59
    s_cbranch_vccz L_skip2
    buffer_load_dwordx4 v[76:79], v2, s[28:31], s49 offen sc1
L_skip2:
    s_branch L_chk
L_ok:
    v_max3_f32 v16, v46, v70, v74
    v_max_f32 v16, v16, v78
    v_sub_f32 v46, v46, v16
    v_sub_f32 v70, v70, v16
    v_sub_f32 v74, v74, v16
    v_sub_f32 v78, v78, v16
    v_exp_f32 v46, v46
    v_exp_f32 v70, v70
    v_exp_f32 v74, v74
    v_exp_f32 v78, v78
    v_mul_f32 v47, v46, v47
    v_mul_f32 v71, v70, v71
    v_mul_f32 v75, v74, v75
    v_mul_f32 v79, v78, v79
    v_mul_f32 v44, v46, v44
    v_mul_f32 v45, v46, v45
    v_mul_f32 v68, v70, v68
    v_mul_f32 v69, v70, v69
    v_mul_f32 v72, v74, v72
    v_mul_f32 v73, v74, v73
    v_mul_f32 v76, v78, v76
    v_mul_f32 v77, v78, v77
    v_add_f32 v18, v47, v71
    v_add_f32 v19, v75, v79
    v_add_f32 v18, v18, v19
    v_rcp_f32 v18, v18
    v_add_f32 v20, v44, v68
    v_add_f32 v72, v72, v76
    v_add_f32 v21, v45, v69
    v_add_f32 v73, v73, v77
    v_add_f32 v20, v20, v72
    v_add_f32 v21, v21, v73
    v_mul_f32 v20, v20, v18
    v_mul_f32 v21, v21, v18
    v_cvt_pk_bf16_f32 v20, v20, v21
    buffer_store_dword v20, v58, s[32:35], s43 offen sc1
L_end:
    s_endpgm
.section .rodata,"a"
.p2align 6
.amdhsa_kernel standalone__gqa_softmax__sampling_kernel
  .amdhsa_next_free_vgpr 216
  .amdhsa_next_free_sgpr 56
  .amdhsa_accum_offset 216
  .amdhsa_group_segment_fixed_size 0
  .amdhsa_kernarg_size 48
  .amdhsa_user_sgpr_count 2
  .amdhsa_user_sgpr_kernarg_segment_ptr 1
  .amdhsa_system_sgpr_workgroup_id_x 1
.end_amdhsa_kernel
```
